```python
import torch

def _softmax(x, axis=-1):
    return torch.softmax(x, dim=axis)
def _gelu(x):
    return torch.nn.functional.gelu(x, approximate="tanh")
def _silu(x):
    return torch.nn.functional.silu(x)
def _sigmoid(x):
    return torch.sigmoid(x)
def _layernorm(x, axis=-1, eps=1e-5):
    m = x.mean(dim=axis, keepdim=True)
    v = x.var(dim=axis, keepdim=True, unbiased=False)
    return (x - m) / torch.sqrt(v + eps)
def _scatter_add(tgt, idx, src, axis=0):
    return tgt.clone().index_add_(axis, idx, src)
def _segment_sum(src, seg, n):
    out = torch.zeros((n,) + src.shape[1:], dtype=src.dtype)
    return out.index_add_(0, seg, src)
def _pad(x, pw):
    flat = tuple(v for pair in reversed(pw) for v in pair)
    return torch.nn.functional.pad(x, flat)

kernel_name = 'gated_mix__gqa_block_cached__dense_activation_gelu__decode'

def setup_inputs():

    _w = (lambda a: (lambda t: t.to(torch.bfloat16) if t.is_floating_point() else t)(torch.as_tensor(a)))
    def _A_setup():
        B, Sq, D = 8, 1, 512
        Hq, Hkv, Sk, Dh = 32, 8, 4096, 128
        assert Hq % Hkv == 0, (Hq, Hkv)
        return {
            "x": _w((lambda *s: torch.randn(*s, dtype=torch.bfloat16) * 0.05)(B, Sq, D)),
            "k_cache": _w((lambda *s: torch.randn(*s, dtype=torch.bfloat16) * 6.4)(B, Hkv, Sk, Dh)),
            "v_cache": _w((lambda *s: torch.randn(*s, dtype=torch.bfloat16) * 0.2)(B, Hkv, Sk, Dh)),
            "wq": _w((lambda *s: torch.randn(*s, dtype=torch.bfloat16) * 6.4)(D, Hq * Dh) * (D ** -0.5)),
            "wo": _w((lambda *s: torch.randn(*s, dtype=torch.bfloat16) * 0.2)(Hq * Dh, D) * ((Hq * Dh) ** -0.5)),
        }
    _A_in = _A_setup()

    def _B_setup():
        B, S, D, F = 8, 1, 512, 1792
        return {
            "x": _w((lambda *s: torch.randn(*s, dtype=torch.bfloat16) * 0.05)(B, S, D)),
            "w1": _w((lambda *s: torch.randn(*s, dtype=torch.bfloat16) * 3.2)(D, F) * (D ** -0.5)),
            "b1": _w((lambda *s: torch.randn(*s, dtype=torch.bfloat16) * 3.2)(F) * 0.01),
            "w2": _w((lambda *s: torch.randn(*s, dtype=torch.bfloat16) * 0.2)(F, D) * (F ** -0.5)),
            "b2": _w((lambda *s: torch.randn(*s, dtype=torch.bfloat16) * 0.4)(D) * 0.01),
        }
    _B_in = _B_setup()

    return {
        "A_x": _A_in["x"],
        "A_k_cache": _A_in["k_cache"],
        "A_v_cache": _A_in["v_cache"],
        "A_wq": _A_in["wq"],
        "A_wo": _A_in["wo"],
        "B_x": _B_in["x"],
        "B_w1": _B_in["w1"],
        "B_b1": _B_in["b1"],
        "B_w2": _B_in["w2"],
        "B_b2": _B_in["b2"],
        "gate_w": _w((lambda *s: torch.randn(*s, dtype=torch.bfloat16) * 0.05)(512) * 16.0),
    }

def reference(A_x, A_k_cache, A_v_cache, A_wq, A_wo, B_x, B_w1, B_b1, B_w2, B_b2, gate_w):
    def _A_ref(x, k_cache, v_cache, wq, wo):
        B, Sq, D = x.shape
        Hq, Dh = 32, 128
        Hkv = k_cache.shape[1]
        rep = Hq // Hkv
        q = (lambda x, *d: x.permute(*d))((x @ wq).reshape(B, Sq, Hq, Dh), 0, 2, 1, 3)
        k = (lambda x, n, axis: torch.repeat_interleave(x, n, dim=axis))(k_cache, rep, axis=1)
        v = (lambda x, n, axis: torch.repeat_interleave(x, n, dim=axis))(v_cache, rep, axis=1)
        scores = torch.einsum("bhqd,bhkd->bhqk", q, k) * (Dh ** -0.5)
        p = _softmax(scores, axis=-1)
        o = torch.einsum("bhqk,bhkd->bhqd", p, v)
        return (lambda x, *d: x.permute(*d))(o, 0, 2, 1, 3).reshape(B, Sq, Hq * Dh) @ wo

    def _B_ref(x, w1, b1, w2, b2):
        h = torch.einsum("bsd,df->bsf", x, w1) + b1
        h = _gelu(h)
        return torch.einsum("bsf,fd->bsd", h, w2) + b2

    x = A_x
    g = _sigmoid((x * gate_w).sum(-1, keepdims=True))
    a = _A_ref(x, A_k_cache, A_v_cache, A_wq, A_wo)
    b = _B_ref(x, B_w1, B_b1, B_w2, B_b2)
    return g * a + (1 - g) * b
```

```asm
; @launch grid=(256,1,1) block=(512,1,1) lds=92256
.amdgcn_target "amdgcn-amd-amdhsa--gfx950"
.text
.p2align 12
.fill 256, 4, 0xbf810000
.globl gated_mix__gqa_block_cached__dense_activation_gelu__decode_kernel
.p2align 8
.type gated_mix__gqa_block_cached__dense_activation_gelu__decode_kernel,@function
gated_mix__gqa_block_cached__dense_activation_gelu__decode_kernel:
  s_load_dwordx16 s[4:19], s[0:1], 0
  s_cmp_ge_u32 s2, 256
  s_cbranch_scc1 L_end
  s_load_dwordx8 s[20:27], s[0:1], 64
  s_load_dwordx4 s[28:31], s[0:1], 96
  v_lshrrev_b32 v119, 6, v0
  v_and_b32 v6, 3, v0
  v_readfirstlane_b32 s32, v119
  v_bfe_u32 v7, v0, 2, 2
  v_bfe_u32 v8, v0, 4, 2
  s_and_b32 s33, s2, 7
  s_lshr_b32 s35, s2, 5
  s_bfe_u32 s36, s2, 0x20003
  v_lshlrev_b32 v3, 4, v6
  v_lshl_add_u32 v3, v7, 8, v3
  v_lshl_add_u32 v3, v8, 6, v3
  s_lshl3_add_u32 s43, s35, s33
  s_lshl2_add_u32 s43, s43, s36
  s_lshl_b32 s43, s43, 18
  s_lshl_b32 s88, s32, 12
  s_mov_b32 s47, 0x20000
  s_mov_b32 s46, 0x40000
  s_lshr_b32 s34, s2, 3
  v_and_b32 v1, 63, v0
  v_lshlrev_b32 v2, 4, v1
  s_lshl_b32 s3, s32, 4
  v_lshrrev_b32 v119, 3, v1
  v_add_u32 v119, s3, v119
  v_and_b32 v120, 1, v8
  v_lshlrev_b32 v120, 1, v120
  v_and_b32 v121, 7, v1
  v_xor_b32 v120, v120, v121
  v_lshlrev_b32 v120, 4, v120
  v_mul_u32_u24 v108, 3584, v119
  v_add_u32 v108, v108, v120
  v_lshl_add_u32 v56, v119, 13, v120
  v_xor_b32 v57, 64, v56
  s_lshl_b32 s3, s32, 12
  s_lshl_b32 s42, s36, 8
  s_add_u32 s3, s3, s42
  v_and_b32 v119, 15, v1
  v_lshl_add_u32 v58, v119, 4, s3
  v_lshl_add_u32 v58, v8, 10, v58
  s_lshl_b32 s38, s36, 20
  s_lshl_b32 s3, s33, 10
  s_add_u32 s38, s38, s3
  s_lshl_b32 s3, s35, 7
  s_add_u32 s38, s38, s3
  s_mov_b32 s55, 0x20000
  s_sub_u32 s54, 0x400000, s38
  s_lshl_b32 s3, s32, 10
  s_add_u32 m0, s3, 82176
  s_mov_b32 s39, 0x10000
  s_waitcnt lgkmcnt(0)
  s_add_u32 s44, s6, s43
  s_addc_u32 s45, s7, 0
  s_load_dword s37, s[30:31], 0
  s_cmp_gt_u32 s32, 1
  s_cbranch_scc1 L_nox
  global_load_lds_dwordx4 v58, s[4:5]
L_nox:
  s_lshl_b32 m0, s32, 11
  s_add_u32 s52, s10, s38
  s_addc_u32 s53, s11, 0
  buffer_load_dwordx4 v56, s[52:55], 0 offen nt lds
  s_add_u32 m0, m0, 1024
  s_nop 0
  buffer_load_dwordx4 v57, s[52:55], s39 offen nt lds
  s_mov_b32 s59, 0x20000
  s_mov_b32 s63, 0x20000
  s_mov_b32 s67, 0x20000
  s_mov_b32 s71, 0x20000
  s_mov_b32 s75, 0x20000
  s_mov_b32 s79, 0x20000
  s_lshl_b32 s39, s35, 3
  s_add_u32 s39, s39, s33
  s_lshl_b32 s38, s33, 3
  s_add_u32 s38, s38, s35
  s_sub_u32 s40, s39, 32
  s_cmp_lt_u32 s40, 28
  s_cselect_b32 s40, s40, 0
  s_cselect_b32 s58, 458752, 0
  s_cselect_b32 s70, 8192, 0
  s_mul_i32 s3, s36, 458752
  s_lshl_b32 s28, s40, 7
  s_add_u32 s3, s3, s28
  s_add_u32 s56, s16, s3
  s_addc_u32 s57, s17, 0
  s_lshl_b32 s3, s40, 13
  s_add_u32 s3, s3, 262144
  s_add_u32 s68, s30, s3
  s_addc_u32 s69, s31, 0
  s_lshl_b32 s3, s38, 16
  s_lshl_b32 s28, s36, 8
  s_add_u32 s3, s3, s28
  s_add_u32 s60, s12, s3
  s_addc_u32 s61, s13, 0
  s_sub_u32 s62, 0x400000, s3
  s_cmp_lt_u32 s39, 28
  s_cselect_b32 s39, s39, 0
  s_cselect_b32 s66, 64768, 0
  s_cselect_b32 s74, 8192, 0
  s_cselect_b32 s78, 128, 0
  s_lshl_b32 s3, s39, 16
  s_add_u32 s3, s3, s28
  s_add_u32 s64, s20, s3
  s_addc_u32 s65, s21, 0
  s_lshl_b32 s3, s39, 13
  s_add_u32 s3, s3, 262144
  s_add_u32 s72, s30, s3
  s_addc_u32 s73, s31, 0
  s_lshl_b32 s3, s39, 7
  s_add_u32 s76, s18, s3
  s_addc_u32 s77, s19, 0
  s_and_b32 s3, s32, 3
  s_lshl_b32 s3, s3, 2
  v_lshrrev_b32 v119, 5, v1
  v_lshl_or_b32 v119, v119, 1, s3
  v_and_b32 v120, 15, v1
  v_xor_b32 v119, v119, v120
  s_lshl_b32 s3, s32, 13
  v_lshl_add_u32 v106, v8, 10, s3
  v_lshl_add_u32 v107, v119, 4, v106
  s_and_b32 s3, s32, 1
  s_lshl_b32 s3, s3, 3
  v_lshl_or_b32 v119, v8, 1, s3
  v_xor_b32 v119, v119, v120
  v_lshl_add_u32 v106, v119, 4, v106
  s_lshl_b32 s3, s32, 11
  s_add_u32 m0, s3, 16384
  s_nop 0
  buffer_load_dwordx4 v108, s[56:59], 0 offen nt lds
  s_add_u32 m0, m0, 1024
  v_xor_b32 v108, 64, v108
  s_movk_i32 s3, 28672
  buffer_load_dwordx4 v108, s[56:59], s3 offen nt lds
  s_lshl_b32 s3, s32, 11
  s_add_u32 m0, s3, 49152
  s_nop 0
  buffer_load_dwordx4 v106, s[64:67], 0 offen nt lds
  s_add_u32 m0, m0, 1024
  s_movk_i32 s3, 4096
  buffer_load_dwordx4 v106, s[64:67], s3 offen nt lds
  s_barrier
  buffer_load_dwordx4 v[128:131], v3, s[44:47], s88 offen offset:0 nt
  v_and_b32 v119, 1, v8
  v_lshrrev_b32 v120, 1, v7
  v_lshl_or_b32 v120, v119, 1, v120
  s_and_b32 s40, s32, 3
  v_xor_b32 v120, s40, v120
  v_lshlrev_b32 v109, 3, v6
  v_lshl_add_u32 v109, v120, 5, v109
  v_lshl_add_u32 v109, v7, 7, v109
  v_lshl_add_u32 v109, v8, 10, v109
  v_and_b32 v121, 7, v1
  v_lshlrev_b32 v110, 8, v121
  v_lshl_add_u32 v110, v8, 4, v110
  v_add_u32 v110, 82176, v110
  v_bfe_u32 v64, v1, 2, 3
  v_lshl_add_u32 v111, v6, 4, v64
  v_lshlrev_b32 v111, 2, v111
  s_lshl_b32 s3, s33, 16
  s_lshl_b32 s42, s34, 8
  s_add_u32 s3, s3, s42
  s_lshl_b32 s42, s40, 6
  s_add_u32 s3, s3, s42
  s_add_u32 s3, s3, 524288
  v_lshl_add_u32 v117, v6, 4, s3
  v_lshl_add_u32 v117, v64, 13, v117
  s_mov_b32 s42, 0xffffff00
  s_mov_b32 s14, 0x0c0c0400
  s_mov_b32 s15, 0x05040100
  s_waitcnt lgkmcnt(0)
  s_add_u32 s37, s37, 0x9e3779b9
  v_mov_b32 v12, s37
  v_bfe_u32 v9, v12, 0, 8
  v_bfe_u32 v10, v12, 8, 8
  v_bfe_u32 v11, v12, 16, 8
  v_lshrrev_b32 v12, 24, v12
  s_lshr_b32 s3, s37, 24
  s_add_u32 s3, s3, 0x40
  s_and_b32 s3, s3, 0xff
  s_and_b32 s80, s37, s42
  s_or_b32 s80, s80, s3
  s_getreg_b32 s83, hwreg(HW_REG_XCC_ID, 0, 4)
  s_lshl_b32 s3, s33, 8
  s_add_u32 s3, s3, 4096
  v_and_b32 v119, 31, v1
  v_lshl_add_u32 v118, v119, 2, s3
  s_xor_b32 s83, s83, s37
  s_lshl_b32 s28, s34, 2
  s_add_u32 s3, s3, s28
  s_add_u32 s84, s30, s3
  s_addc_u32 s85, s31, 0
  s_mov_b32 s86, 4
  s_mov_b32 s87, 0x20000
  v_mov_b32 v120, s83
  v_and_b32 v121, 7, v1
  v_mul_u32_u24 v113, 160, v121
  v_lshl_add_u32 v113, v8, 4, v113
  v_add_u32 v113, 85248, v113
  s_lshl_b32 s3, s32, 7
  s_add_u32 s3, s3, 84224
  v_lshl_add_u32 v112, v6, 3, s3
  v_lshl_add_u32 v112, v8, 5, v112
  s_add_u32 s48, s8, s43
  s_addc_u32 s49, s9, 0
  s_mov_b32 s50, 0x40000
  s_mov_b32 s51, 0x20000
  s_cmp_lg_u32 s74, 0
  s_cselect_b32 s41, s37, 0
  s_mov_b32 s89, 0x3e0293ee
  v_and_b32 v119, 1, v1
  v_lshlrev_b32 v119, 4, v119
  v_mov_b32 v120, 0xffff
  v_lshlrev_b32 v119, v119, v120
  v_bfe_i32 v120, v1, 1, 1
  v_and_b32 v5, v119, v120
  v_xor_b32 v4, v119, v5
  v_mov_b32 v119, s89
  v_cmp_eq_u32 vcc, 0, v6
  s_nop 1
  v_cndmask_b32 v20, 0, v119, vcc
  v_cmp_eq_u32 vcc, 1, v6
  s_nop 1
  v_cndmask_b32 v21, 0, v119, vcc
  v_cmp_eq_u32 vcc, 2, v6
  s_nop 1
  v_cndmask_b32 v22, 0, v119, vcc
  v_cmp_eq_u32 vcc, 3, v6
  s_nop 1
  v_cndmask_b32 v23, 0, v119, vcc
  s_and_b32 s81, s32, 3
  s_lshl_b32 s81, s81, 1
  v_and_b32 v119, 1, v8
  v_lshl_or_b32 v120, v7, 1, v119
  v_xor_b32 v120, s81, v120
  v_lshlrev_b32 v114, 3, v6
  v_lshl_add_u32 v114, v120, 5, v114
  v_lshl_add_u32 v114, v7, 11, v114
  v_lshl_add_u32 v114, v8, 9, v114
  v_lshl_or_b32 v120, v119, 2, v7
  v_xor_b32 v120, s81, v120
  v_lshlrev_b32 v115, 3, v6
  v_lshl_add_u32 v115, v120, 5, v115
  v_lshl_add_u32 v115, v7, 8, v115
  v_lshl_add_u32 v115, v8, 11, v115
  s_lshl_b32 s3, s32, 10
  v_add_u32 v105, s3, v3
  s_lshl_b32 s3, s33, 3
  s_add_u32 s3, s3, s35
  s_lshl_b32 s3, s3, 13
  s_add_u32 s3, s3, 524288
  v_add_u32 v104, s3, v105
  s_waitcnt vmcnt(5)
  s_cmp_lg_u32 s32, 4
  s_cbranch_scc1 L_noid
  v_mov_b32 v120, s83
  buffer_store_dword v120, v2, s[84:87], 0 offen
L_noid:
  s_barrier
  s_cmp_gt_u32 s32, 3
  s_cbranch_scc1 L_p0_done
  ds_read_b128 v[80:83], v110 offset:0
  ds_read_b64_tr_b16 v[64:65], v109 offset:0
  ds_read_b64_tr_b16 v[66:67], v109 offset:512
  ds_read_b128 v[84:87], v110 offset:64
  ds_read_b64_tr_b16 v[68:69], v109 offset:4096
  ds_read_b64_tr_b16 v[70:71], v109 offset:4608
  ds_read_b128 v[88:91], v110 offset:128
  ds_read_b64_tr_b16 v[72:73], v109 offset:8192
  ds_read_b64_tr_b16 v[74:75], v109 offset:8704
  ds_read_b128 v[92:95], v110 offset:192
  ds_read_b64_tr_b16 v[76:77], v109 offset:12288
  ds_read_b64_tr_b16 v[78:79], v109 offset:12800
  s_waitcnt lgkmcnt(9)
  v_mfma_f32_16x16x32_bf16 v[28:31], v[64:67], v[80:83], 0
  s_waitcnt lgkmcnt(6)
  v_mfma_f32_16x16x32_bf16 v[28:31], v[68:71], v[84:87], v[28:31]
  s_waitcnt lgkmcnt(3)
  v_mfma_f32_16x16x32_bf16 v[28:31], v[72:75], v[88:91], v[28:31]
  s_waitcnt lgkmcnt(0)
  v_mfma_f32_16x16x32_bf16 v[28:31], v[76:79], v[92:95], v[28:31]
  s_nop 7
  v_and_or_b32 v28, v28, s42, v9
  v_and_or_b32 v29, v29, s42, v10
  v_and_or_b32 v30, v30, s42, v11
  v_and_or_b32 v31, v31, s42, v12
  ds_bpermute_b32 v32, v111, v28
  ds_bpermute_b32 v33, v111, v29
  ds_bpermute_b32 v34, v111, v30
  ds_bpermute_b32 v35, v111, v31
  s_waitcnt lgkmcnt(0)
L_p0_done:
  s_sub_u32 s89, s2, 228
  s_lshr_b32 s3, s89, 3
  s_and_b32 s89, s89, 7
  s_cmp_eq_u32 s89, 0
  s_cselect_b32 s89, s3, 99
  s_cmp_gt_u32 s89, 3
  s_cbranch_scc1 L_nopre
  s_lshl3_add_u32 s43, s89, s32
  s_lshl_b32 s43, s43, 7
  s_add_u32 s43, s43, 32768
  v_lshl_add_u32 v119, v1, 13, s43
  v_mov_b32 v120, s37
  s_mov_b64 exec, 3
  global_store_dword v119, v120, s[30:31] sc1
  s_mov_b64 exec, -1
L_nopre:
  buffer_load_dwordx4 v[132:135], v3, s[44:47], s88 offen offset:1024 nt
  buffer_load_dwordx4 v[136:139], v3, s[44:47], s88 offen offset:2048 nt
  s_waitcnt vmcnt(2)
  buffer_load_dwordx4 v[140:143], v3, s[44:47], s88 offen offset:3072 nt
  s_xor_b32 s88, s88, 32768
  s_waitcnt vmcnt(2)
  buffer_load_dwordx4 v[144:147], v3, s[44:47], s88 offen offset:0 nt
  s_waitcnt vmcnt(2)
  buffer_load_dwordx4 v[148:151], v3, s[44:47], s88 offen offset:1024 nt
  s_waitcnt vmcnt(2)
  buffer_load_dwordx4 v[152:155], v3, s[44:47], s88 offen offset:2048 nt
  s_waitcnt vmcnt(2)
  buffer_load_dwordx4 v[156:159], v3, s[44:47], s88 offen offset:3072 nt
  s_xor_b32 s88, s88, 98304
  s_waitcnt vmcnt(2)
  buffer_load_dwordx4 v[160:163], v3, s[44:47], s88 offen offset:0 nt
  global_load_dword v24, v118, s[30:31] sc1
  s_waitcnt vmcnt(3)
  buffer_load_dwordx4 v[164:167], v3, s[44:47], s88 offen offset:1024 nt
  s_waitcnt vmcnt(3)
  buffer_load_dwordx4 v[168:171], v3, s[44:47], s88 offen offset:2048 nt
  s_waitcnt vmcnt(3)
  buffer_load_dwordx4 v[172:175], v3, s[44:47], s88 offen offset:3072 nt
  s_xor_b32 s88, s88, 32768
  s_waitcnt vmcnt(2)
  buffer_load_dwordx4 v[176:179], v3, s[44:47], s88 offen offset:0 nt
  v_cmp_ne_u32 vcc, s83, v24
  s_or_b32 s82, vcc_lo, 0
  s_cmp_gt_u32 s32, 3
  s_cbranch_scc1 L_qp_done
  s_mov_b32 exec_hi, 0
  s_cmp_eq_u32 s82, 0
  s_cbranch_scc1 L_qp_loc
  global_store_dwordx4 v117, v[32:35], s[30:31] sc1
  s_branch L_qp_st
L_qp_loc:
  global_store_dwordx4 v117, v[32:35], s[30:31]
L_qp_st:
  s_mov_b32 exec_hi, -1
  s_nop 1
L_qp_done:
  s_waitcnt lgkmcnt(0)
  s_cmp_gt_u32 s89, 3
  s_cbranch_scc1 L_norace
  s_and_b32 s28, s32, 1
  s_lshl_b32 s28, s28, 13
  s_add_u32 s28, s28, s43
  s_xor_b32 s29, s28, 0x2000
  s_not_b32 s17, s37
  s_load_dword s16, s[30:31], s28
  s_load_dword s17, s[30:31], s29
  s_waitcnt lgkmcnt(1)
  s_cmp_lg_u32 s17, s37
  s_cselect_b32 s43, 1, 0
  s_waitcnt lgkmcnt(0)
  s_sub_u32 s3, 0, s43
  s_bitcmp1_b32 s32, 0
  s_cselect_b32 s43, s3, s43
  s_lshl_b32 s3, s32, 2
  s_add_u32 s3, s3, 88128
  v_mov_b32 v119, s3
  v_mov_b32 v120, s43
  ds_write_b32 v119, v120
  s_waitcnt lgkmcnt(0)
L_norace:
  s_waitcnt vmcnt(2)
  buffer_load_dwordx4 v[180:183], v3, s[44:47], s88 offen offset:1024 nt
  s_lshl_b32 s3, s32, 10
  v_add_u32 v119, s3, v2
  global_load_dwordx4 v[80:83], v119, s[4:5]
  global_load_dwordx4 v[84:87], v2, s[24:25]
  v_lshlrev_b32 v119, 3, v6
  v_lshl_add_u32 v119, v8, 5, v119
  buffer_load_dwordx2 v[122:123], v119, s[76:79], 0 offen
  s_and_b32 s3, s34, 15
  s_lshl_b32 s28, s33, 4
  s_add_u32 s3, s3, s28
  s_lshl_b32 s3, s3, 3
  v_lshl_add_u32 v119, v6, 1, s3
  global_load_ushort v116, v119, s[22:23]
  s_waitcnt vmcnt(6)
  buffer_load_dwordx4 v[184:187], v3, s[44:47], s88 offen offset:2048 nt
  s_waitcnt vmcnt(6)
  buffer_load_dwordx4 v[188:191], v3, s[44:47], s88 offen offset:3072 nt
  s_xor_b32 s88, s88, 229376
  s_waitcnt vmcnt(6)
  buffer_load_dwordx4 v[192:195], v3, s[44:47], s88 offen offset:0 nt
  s_waitcnt vmcnt(2)
  buffer_load_dwordx4 v[196:199], v3, s[44:47], s88 offen offset:1024 nt
  v_dot2_f32_bf16 v13, v80, v84, 0
  v_dot2_f32_bf16 v13, v81, v85, v13
  v_dot2_f32_bf16 v13, v82, v86, v13
  v_dot2_f32_bf16 v13, v83, v87, v13
  s_nop 2
  v_add_f32_dpp v13, v13, v13 quad_perm:[1,0,3,2] row_mask:0xf bank_mask:0xf
  s_nop 1
  v_add_f32_dpp v13, v13, v13 quad_perm:[2,3,0,1] row_mask:0xf bank_mask:0xf
  s_nop 1
  v_add_f32_dpp v13, v13, v13 row_ror:8 row_mask:0xf bank_mask:0xf
  s_nop 1
  v_add_f32_dpp v13, v13, v13 row_ror:4 row_mask:0xf bank_mask:0xf
  v_mov_b32 v119, v13
  s_nop 1
  v_permlane32_swap_b32 v13, v119
  v_add_f32 v13, v13, v119
  v_mov_b32 v119, v13
  s_nop 1
  v_permlane16_swap_b32 v13, v119
  v_add_f32 v13, v13, v119
  v_mul_f32 v13, 0xbfb8aa3b, v13
  v_exp_f32 v13, v13
  s_lshl_b32 s3, s32, 2
  s_add_u32 s3, s3, 88064
  v_add_f32 v13, 1.0, v13
  v_mov_b32 v119, s3
  v_rcp_f32 v13, v13
  s_nop 0
  ds_write_b32 v119, v13
  s_waitcnt vmcnt(2)
  buffer_load_dwordx4 v[200:203], v3, s[44:47], s88 offen offset:2048 nt
  global_load_dword v24, v118, s[30:31] sc1
  global_load_dwordx4 v[56:59], v104, s[30:31] sc1
  s_waitcnt vmcnt(4)
  buffer_load_dwordx4 v[204:207], v3, s[44:47], s88 offen offset:3072 nt
  s_xor_b32 s88, s88, 32768
  s_waitcnt vmcnt(4)
  buffer_load_dwordx4 v[208:211], v3, s[44:47], s88 offen offset:0 nt
  s_waitcnt vmcnt(4)
  buffer_load_dwordx4 v[212:215], v3, s[44:47], s88 offen offset:1024 nt
  s_waitcnt vmcnt(2)
  buffer_load_dwordx4 v[216:219], v3, s[44:47], s88 offen offset:2048 nt
  s_mov_b32 s3, 4000000
L_q_chk:
  v_perm_b32 v64, v57, v56, s14
  v_perm_b32 v65, v59, v58, s14
  v_perm_b32 v64, v65, v64, s15
  v_cmp_ne_u32 vcc, s37, v64
  s_cbranch_vccz L_q_ok
  s_sub_u32 s3, s3, 1
  s_cbranch_scc1 L_q_ok
  global_load_dwordx4 v[56:59], v104, s[30:31] sc1
  s_waitcnt vmcnt(0)
  s_branch L_q_chk
L_q_ok:
  v_and_b32 v56, s42, v56
  v_and_b32 v57, s42, v57
  v_and_b32 v58, s42, v58
  v_and_b32 v59, s42, v59
  v_add_f32_dpp v56, v56, v56 row_ror:8 row_mask:0xf bank_mask:0xf
  v_add_f32_dpp v57, v57, v57 row_ror:8 row_mask:0xf bank_mask:0xf
  v_add_f32_dpp v58, v58, v58 row_ror:8 row_mask:0xf bank_mask:0xf
  v_add_f32_dpp v59, v59, v59 row_ror:8 row_mask:0xf bank_mask:0xf
  v_add_f32_dpp v56, v56, v56 row_ror:4 row_mask:0xf bank_mask:0xf
  v_add_f32_dpp v57, v57, v57 row_ror:4 row_mask:0xf bank_mask:0xf
  v_add_f32_dpp v58, v58, v58 row_ror:4 row_mask:0xf bank_mask:0xf
  v_add_f32_dpp v59, v59, v59 row_ror:4 row_mask:0xf bank_mask:0xf
  v_cvt_pk_bf16_f32 v56, v56, v57
  v_cvt_pk_bf16_f32 v57, v58, v59
  v_cmp_ne_u32 vcc, s83, v24
  ds_write_b64 v112, v[56:57]
  s_or_b32 s82, vcc_lo, 0
  s_mul_i32 s3, s32, 32
  s_add_u32 s3, s3, 1024
  v_add_u32 v112, s3, v112
  s_waitcnt vmcnt(2)
  buffer_load_dwordx4 v[220:223], v3, s[44:47], s88 offen offset:3072 nt
  s_xor_b32 s88, s88, 98304
  s_waitcnt vmcnt(2)
  buffer_load_dwordx4 v[224:227], v3, s[44:47], s88 offen offset:0 nt
  s_waitcnt lgkmcnt(0)
  s_barrier
  v_add_u32 v119, 84224, v3
  ds_read_b128 v[16:19], v119
  s_cmp_lg_u32 s32, 3
  s_cbranch_scc1 L_ct_done
  s_add_u32 s84, s84, 128
  s_addc_u32 s85, s85, 0
  v_mov_b32 v120, s37
  s_mov_b32 exec_hi, 0
  s_cmp_eq_u32 s82, 0
  s_cbranch_scc1 L_ct_loc
  buffer_store_dword v120, v2, s[84:87], 0 offen sc1
  s_branch L_ct_st
L_ct_loc:
  buffer_store_dword v120, v2, s[84:87], 0 offen
L_ct_st:
  s_mov_b32 exec_hi, -1
  s_nop 1
L_ct_done:
  s_cmp_lt_u32 s32, 4
  s_cselect_b32 s3, 0, s70
  s_waitcnt lgkmcnt(0)
  s_cmp_eq_u32 s3, 0
  s_cbranch_scc1 L_h_done
  s_lshl_b32 s3, s36, 8
  s_and_b32 s28, s32, 3
  s_lshl_b32 s28, s28, 6
  s_add_u32 s3, s3, s28
  v_bfe_u32 v120, v1, 2, 3
  v_lshl_add_u32 v119, v6, 4, s3
  v_lshl_add_u32 v119, v120, 10, v119
  ds_read_b128 v[80:83], v110 offset:0
  ds_read_b64_tr_b16 v[64:65], v109 offset:16384
  ds_read_b64_tr_b16 v[66:67], v109 offset:16896
  ds_read_b128 v[84:87], v110 offset:64
  ds_read_b64_tr_b16 v[68:69], v109 offset:20480
  ds_read_b64_tr_b16 v[70:71], v109 offset:20992
  ds_read_b128 v[88:91], v110 offset:128
  ds_read_b64_tr_b16 v[72:73], v109 offset:24576
  ds_read_b64_tr_b16 v[74:75], v109 offset:25088
  ds_read_b128 v[92:95], v110 offset:192
  ds_read_b64_tr_b16 v[76:77], v109 offset:28672
  ds_read_b64_tr_b16 v[78:79], v109 offset:29184
  s_waitcnt lgkmcnt(9)
  v_mfma_f32_16x16x32_bf16 v[28:31], v[64:67], v[80:83], 0
  s_waitcnt lgkmcnt(6)
  v_mfma_f32_16x16x32_bf16 v[28:31], v[68:71], v[84:87], v[28:31]
  s_waitcnt lgkmcnt(3)
  v_mfma_f32_16x16x32_bf16 v[28:31], v[72:75], v[88:91], v[28:31]
  s_waitcnt lgkmcnt(0)
  v_mfma_f32_16x16x32_bf16 v[28:31], v[76:79], v[92:95], v[28:31]
  s_nop 7
  v_and_or_b32 v28, v28, s42, v9
  v_and_or_b32 v29, v29, s42, v10
  v_and_or_b32 v30, v30, s42, v11
  v_and_or_b32 v31, v31, s42, v12
  ds_bpermute_b32 v32, v111, v28
  ds_bpermute_b32 v33, v111, v29
  ds_bpermute_b32 v34, v111, v30
  ds_bpermute_b32 v35, v111, v31
  s_waitcnt lgkmcnt(0)
  s_mov_b32 exec_hi, 0
  s_cmp_eq_u32 s82, 0
  s_cbranch_scc1 L_hp_loc
  buffer_store_dwordx4 v[32:35], v119, s[68:71], 0 offen sc1
  s_branch L_hp_st
L_hp_loc:
  buffer_store_dwordx4 v[32:35], v119, s[68:71], 0 offen
L_hp_st:
  s_mov_b32 exec_hi, -1
  s_nop 1
L_h_done:
  s_cmp_lg_u32 s32, 5
  s_cbranch_scc1 L_novote
  s_cmp_gt_u32 s89, 3
  s_cbranch_scc1 L_novote
  v_mov_b32 v119, 88128
  ds_read_b128 v[64:67], v119
  ds_read_b128 v[68:71], v119 offset:16
  s_lshl_b32 s3, s89, 3
  s_add_u32 s3, s3, 8192
  v_mov_b32 v119, s3
  s_waitcnt lgkmcnt(0)
  v_add3_u32 v65, v64, v65, v66
  v_add3_u32 v67, v67, v68, v69
  v_add3_u32 v65, v65, v70, v71
  v_add_u32 v65, v65, v67
  v_mov_b32 v64, s37
  s_mov_b64 exec, 1
  global_store_dwordx2 v119, v[64:65], s[30:31] sc1
  s_mov_b64 exec, -1
L_novote:
  s_waitcnt vmcnt(2)
  buffer_load_dwordx4 v[228:231], v3, s[44:47], s88 offen offset:1024 nt
  v_mfma_f32_16x16x32_bf16 v[28:31], v[128:131], v[16:19], 0
  v_mfma_f32_16x16x32_bf16 v[32:35], v[132:135], v[16:19], 0
  s_nop 6
  v_mul_f32_dpp v24, v28, v20 quad_perm:[0,0,0,0] row_mask:0xf bank_mask:0xf
  v_mul_f32_dpp v25, v29, v20 quad_perm:[1,1,1,1] row_mask:0xf bank_mask:0xf
  v_mul_f32_dpp v26, v30, v20 quad_perm:[2,2,2,2] row_mask:0xf bank_mask:0xf
  v_mul_f32_dpp v27, v31, v20 quad_perm:[3,3,3,3] row_mask:0xf bank_mask:0xf
  v_mfma_f32_16x16x32_bf16 v[28:31], v[136:139], v[16:19], 0
  v_fmac_f32_dpp v24, v32, v21 quad_perm:[0,0,0,0] row_mask:0xf bank_mask:0xf
  v_fmac_f32_dpp v25, v33, v21 quad_perm:[1,1,1,1] row_mask:0xf bank_mask:0xf
  v_fmac_f32_dpp v26, v34, v21 quad_perm:[2,2,2,2] row_mask:0xf bank_mask:0xf
  v_fmac_f32_dpp v27, v35, v21 quad_perm:[3,3,3,3] row_mask:0xf bank_mask:0xf
  v_mfma_f32_16x16x32_bf16 v[32:35], v[140:143], v[16:19], 0
  s_nop 2
  v_fmac_f32_dpp v24, v28, v22 quad_perm:[0,0,0,0] row_mask:0xf bank_mask:0xf
  v_fmac_f32_dpp v25, v29, v22 quad_perm:[1,1,1,1] row_mask:0xf bank_mask:0xf
  v_fmac_f32_dpp v26, v30, v22 quad_perm:[2,2,2,2] row_mask:0xf bank_mask:0xf
  v_fmac_f32_dpp v27, v31, v22 quad_perm:[3,3,3,3] row_mask:0xf bank_mask:0xf
  s_waitcnt vmcnt(2)
  buffer_load_dwordx4 v[232:235], v3, s[44:47], s88 offen offset:2048 nt
  v_mfma_f32_16x16x32_bf16 v[28:31], v[144:147], v[16:19], 0
  v_fmac_f32_dpp v24, v32, v23 quad_perm:[0,0,0,0] row_mask:0xf bank_mask:0xf
  v_fmac_f32_dpp v25, v33, v23 quad_perm:[1,1,1,1] row_mask:0xf bank_mask:0xf
  v_fmac_f32_dpp v26, v34, v23 quad_perm:[2,2,2,2] row_mask:0xf bank_mask:0xf
  v_fmac_f32_dpp v27, v35, v23 quad_perm:[3,3,3,3] row_mask:0xf bank_mask:0xf
  v_add_f32 v119, v24, v25
  v_add_f32 v120, v26, v27
  v_add_f32 v36, v119, v120
  v_mfma_f32_16x16x32_bf16 v[32:35], v[148:151], v[16:19], 0
  v_mul_f32_dpp v24, v28, v20 quad_perm:[0,0,0,0] row_mask:0xf bank_mask:0xf
  v_mul_f32_dpp v25, v29, v20 quad_perm:[1,1,1,1] row_mask:0xf bank_mask:0xf
  v_mul_f32_dpp v26, v30, v20 quad_perm:[2,2,2,2] row_mask:0xf bank_mask:0xf
  v_mul_f32_dpp v27, v31, v20 quad_perm:[3,3,3,3] row_mask:0xf bank_mask:0xf
  v_mfma_f32_16x16x32_bf16 v[28:31], v[152:155], v[16:19], 0
  s_nop 2
  v_fmac_f32_dpp v24, v32, v21 quad_perm:[0,0,0,0] row_mask:0xf bank_mask:0xf
  v_fmac_f32_dpp v25, v33, v21 quad_perm:[1,1,1,1] row_mask:0xf bank_mask:0xf
  v_fmac_f32_dpp v26, v34, v21 quad_perm:[2,2,2,2] row_mask:0xf bank_mask:0xf
  v_fmac_f32_dpp v27, v35, v21 quad_perm:[3,3,3,3] row_mask:0xf bank_mask:0xf
  v_mfma_f32_16x16x32_bf16 v[32:35], v[156:159], v[16:19], 0
  v_fmac_f32_dpp v24, v28, v22 quad_perm:[0,0,0,0] row_mask:0xf bank_mask:0xf
  v_fmac_f32_dpp v25, v29, v22 quad_perm:[1,1,1,1] row_mask:0xf bank_mask:0xf
  v_fmac_f32_dpp v26, v30, v22 quad_perm:[2,2,2,2] row_mask:0xf bank_mask:0xf
  v_fmac_f32_dpp v27, v31, v22 quad_perm:[3,3,3,3] row_mask:0xf bank_mask:0xf
  s_waitcnt vmcnt(2)
  buffer_load_dwordx4 v[236:239], v3, s[44:47], s88 offen offset:3072 nt
  s_xor_b32 s88, s88, 32768
  v_mfma_f32_16x16x32_bf16 v[28:31], v[160:163], v[16:19], 0
  v_fmac_f32_dpp v24, v32, v23 quad_perm:[0,0,0,0] row_mask:0xf bank_mask:0xf
  v_fmac_f32_dpp v25, v33, v23 quad_perm:[1,1,1,1] row_mask:0xf bank_mask:0xf
  v_fmac_f32_dpp v26, v34, v23 quad_perm:[2,2,2,2] row_mask:0xf bank_mask:0xf
  v_fmac_f32_dpp v27, v35, v23 quad_perm:[3,3,3,3] row_mask:0xf bank_mask:0xf
  v_add_f32 v119, v24, v25
  v_add_f32 v120, v26, v27
  v_add_f32 v37, v119, v120
  v_mfma_f32_16x16x32_bf16 v[32:35], v[164:167], v[16:19], 0
  v_mul_f32_dpp v24, v28, v20 quad_perm:[0,0,0,0] row_mask:0xf bank_mask:0xf
  v_mul_f32_dpp v25, v29, v20 quad_perm:[1,1,1,1] row_mask:0xf bank_mask:0xf
  v_mul_f32_dpp v26, v30, v20 quad_perm:[2,2,2,2] row_mask:0xf bank_mask:0xf
  v_mul_f32_dpp v27, v31, v20 quad_perm:[3,3,3,3] row_mask:0xf bank_mask:0xf
  v_mfma_f32_16x16x32_bf16 v[28:31], v[168:171], v[16:19], 0
  s_nop 2
  v_fmac_f32_dpp v24, v32, v21 quad_perm:[0,0,0,0] row_mask:0xf bank_mask:0xf
  v_fmac_f32_dpp v25, v33, v21 quad_perm:[1,1,1,1] row_mask:0xf bank_mask:0xf
  v_fmac_f32_dpp v26, v34, v21 quad_perm:[2,2,2,2] row_mask:0xf bank_mask:0xf
  v_fmac_f32_dpp v27, v35, v21 quad_perm:[3,3,3,3] row_mask:0xf bank_mask:0xf
  v_mfma_f32_16x16x32_bf16 v[32:35], v[172:175], v[16:19], 0
  v_fmac_f32_dpp v24, v28, v22 quad_perm:[0,0,0,0] row_mask:0xf bank_mask:0xf
  v_fmac_f32_dpp v25, v29, v22 quad_perm:[1,1,1,1] row_mask:0xf bank_mask:0xf
  v_fmac_f32_dpp v26, v30, v22 quad_perm:[2,2,2,2] row_mask:0xf bank_mask:0xf
  v_fmac_f32_dpp v27, v31, v22 quad_perm:[3,3,3,3] row_mask:0xf bank_mask:0xf
  s_waitcnt vmcnt(2)
  buffer_load_dwordx4 v[240:243], v3, s[44:47], s88 offen offset:0 nt
  v_mfma_f32_16x16x32_bf16 v[28:31], v[176:179], v[16:19], 0
  s_nop 0
  v_fmac_f32_dpp v24, v32, v23 quad_perm:[0,0,0,0] row_mask:0xf bank_mask:0xf
  v_fmac_f32_dpp v25, v33, v23 quad_perm:[1,1,1,1] row_mask:0xf bank_mask:0xf
  v_fmac_f32_dpp v26, v34, v23 quad_perm:[2,2,2,2] row_mask:0xf bank_mask:0xf
  v_fmac_f32_dpp v27, v35, v23 quad_perm:[3,3,3,3] row_mask:0xf bank_mask:0xf
  v_add_f32 v119, v24, v25
  v_add_f32 v120, v26, v27
  v_add_f32 v38, v119, v120
  v_mfma_f32_16x16x32_bf16 v[32:35], v[180:183], v[16:19], 0
  v_mul_f32_dpp v24, v28, v20 quad_perm:[0,0,0,0] row_mask:0xf bank_mask:0xf
  v_mul_f32_dpp v25, v29, v20 quad_perm:[1,1,1,1] row_mask:0xf bank_mask:0xf
  v_mul_f32_dpp v26, v30, v20 quad_perm:[2,2,2,2] row_mask:0xf bank_mask:0xf
  v_mul_f32_dpp v27, v31, v20 quad_perm:[3,3,3,3] row_mask:0xf bank_mask:0xf
  v_mfma_f32_16x16x32_bf16 v[28:31], v[184:187], v[16:19], 0
  s_nop 2
  v_fmac_f32_dpp v24, v32, v21 quad_perm:[0,0,0,0] row_mask:0xf bank_mask:0xf
  v_fmac_f32_dpp v25, v33, v21 quad_perm:[1,1,1,1] row_mask:0xf bank_mask:0xf
  v_fmac_f32_dpp v26, v34, v21 quad_perm:[2,2,2,2] row_mask:0xf bank_mask:0xf
  v_fmac_f32_dpp v27, v35, v21 quad_perm:[3,3,3,3] row_mask:0xf bank_mask:0xf
  v_mfma_f32_16x16x32_bf16 v[32:35], v[188:191], v[16:19], 0
  v_fmac_f32_dpp v24, v28, v22 quad_perm:[0,0,0,0] row_mask:0xf bank_mask:0xf
  v_fmac_f32_dpp v25, v29, v22 quad_perm:[1,1,1,1] row_mask:0xf bank_mask:0xf
  v_fmac_f32_dpp v26, v30, v22 quad_perm:[2,2,2,2] row_mask:0xf bank_mask:0xf
  v_fmac_f32_dpp v27, v31, v22 quad_perm:[3,3,3,3] row_mask:0xf bank_mask:0xf
  s_waitcnt vmcnt(2)
  buffer_load_dwordx4 v[244:247], v3, s[44:47], s88 offen offset:1024 nt
  v_mfma_f32_16x16x32_bf16 v[28:31], v[192:195], v[16:19], 0
  s_nop 0
  v_fmac_f32_dpp v24, v32, v23 quad_perm:[0,0,0,0] row_mask:0xf bank_mask:0xf
  v_fmac_f32_dpp v25, v33, v23 quad_perm:[1,1,1,1] row_mask:0xf bank_mask:0xf
  v_fmac_f32_dpp v26, v34, v23 quad_perm:[2,2,2,2] row_mask:0xf bank_mask:0xf
  v_fmac_f32_dpp v27, v35, v23 quad_perm:[3,3,3,3] row_mask:0xf bank_mask:0xf
  v_add_f32 v119, v24, v25
  v_add_f32 v120, v26, v27
  v_add_f32 v39, v119, v120
  v_mfma_f32_16x16x32_bf16 v[32:35], v[196:199], v[16:19], 0
  v_mul_f32_dpp v24, v28, v20 quad_perm:[0,0,0,0] row_mask:0xf bank_mask:0xf
  v_mul_f32_dpp v25, v29, v20 quad_perm:[1,1,1,1] row_mask:0xf bank_mask:0xf
  v_mul_f32_dpp v26, v30, v20 quad_perm:[2,2,2,2] row_mask:0xf bank_mask:0xf
  v_mul_f32_dpp v27, v31, v20 quad_perm:[3,3,3,3] row_mask:0xf bank_mask:0xf
  v_mfma_f32_16x16x32_bf16 v[28:31], v[200:203], v[16:19], 0
  s_nop 2
  v_fmac_f32_dpp v24, v32, v21 quad_perm:[0,0,0,0] row_mask:0xf bank_mask:0xf
  v_fmac_f32_dpp v25, v33, v21 quad_perm:[1,1,1,1] row_mask:0xf bank_mask:0xf
  v_fmac_f32_dpp v26, v34, v21 quad_perm:[2,2,2,2] row_mask:0xf bank_mask:0xf
  v_fmac_f32_dpp v27, v35, v21 quad_perm:[3,3,3,3] row_mask:0xf bank_mask:0xf
  v_mfma_f32_16x16x32_bf16 v[32:35], v[204:207], v[16:19], 0
  v_fmac_f32_dpp v24, v28, v22 quad_perm:[0,0,0,0] row_mask:0xf bank_mask:0xf
  v_fmac_f32_dpp v25, v29, v22 quad_perm:[1,1,1,1] row_mask:0xf bank_mask:0xf
  v_fmac_f32_dpp v26, v30, v22 quad_perm:[2,2,2,2] row_mask:0xf bank_mask:0xf
  v_fmac_f32_dpp v27, v31, v22 quad_perm:[3,3,3,3] row_mask:0xf bank_mask:0xf
  s_waitcnt vmcnt(2)
  buffer_load_dwordx4 v[248:251], v3, s[44:47], s88 offen offset:2048 nt
  v_mfma_f32_16x16x32_bf16 v[28:31], v[208:211], v[16:19], 0
  s_nop 0
  v_fmac_f32_dpp v24, v32, v23 quad_perm:[0,0,0,0] row_mask:0xf bank_mask:0xf
  v_fmac_f32_dpp v25, v33, v23 quad_perm:[1,1,1,1] row_mask:0xf bank_mask:0xf
  v_fmac_f32_dpp v26, v34, v23 quad_perm:[2,2,2,2] row_mask:0xf bank_mask:0xf
  v_fmac_f32_dpp v27, v35, v23 quad_perm:[3,3,3,3] row_mask:0xf bank_mask:0xf
  v_add_f32 v119, v24, v25
  v_add_f32 v120, v26, v27
  v_add_f32 v40, v119, v120
  v_mfma_f32_16x16x32_bf16 v[32:35], v[212:215], v[16:19], 0
  v_mul_f32_dpp v24, v28, v20 quad_perm:[0,0,0,0] row_mask:0xf bank_mask:0xf
  v_mul_f32_dpp v25, v29, v20 quad_perm:[1,1,1,1] row_mask:0xf bank_mask:0xf
  v_mul_f32_dpp v26, v30, v20 quad_perm:[2,2,2,2] row_mask:0xf bank_mask:0xf
  v_mul_f32_dpp v27, v31, v20 quad_perm:[3,3,3,3] row_mask:0xf bank_mask:0xf
  v_mfma_f32_16x16x32_bf16 v[28:31], v[216:219], v[16:19], 0
  s_nop 2
  v_fmac_f32_dpp v24, v32, v21 quad_perm:[0,0,0,0] row_mask:0xf bank_mask:0xf
  v_fmac_f32_dpp v25, v33, v21 quad_perm:[1,1,1,1] row_mask:0xf bank_mask:0xf
  v_fmac_f32_dpp v26, v34, v21 quad_perm:[2,2,2,2] row_mask:0xf bank_mask:0xf
  v_fmac_f32_dpp v27, v35, v21 quad_perm:[3,3,3,3] row_mask:0xf bank_mask:0xf
  v_mfma_f32_16x16x32_bf16 v[32:35], v[220:223], v[16:19], 0
  v_fmac_f32_dpp v24, v28, v22 quad_perm:[0,0,0,0] row_mask:0xf bank_mask:0xf
  v_fmac_f32_dpp v25, v29, v22 quad_perm:[1,1,1,1] row_mask:0xf bank_mask:0xf
  v_fmac_f32_dpp v26, v30, v22 quad_perm:[2,2,2,2] row_mask:0xf bank_mask:0xf
  v_fmac_f32_dpp v27, v31, v22 quad_perm:[3,3,3,3] row_mask:0xf bank_mask:0xf
  s_waitcnt vmcnt(2)
  buffer_load_dwordx4 v[252:255], v3, s[44:47], s88 offen offset:3072 nt
  s_xor_b32 s88, s88, 229376
  v_mfma_f32_16x16x32_bf16 v[28:31], v[224:227], v[16:19], 0
  v_fmac_f32_dpp v24, v32, v23 quad_perm:[0,0,0,0] row_mask:0xf bank_mask:0xf
  v_fmac_f32_dpp v25, v33, v23 quad_perm:[1,1,1,1] row_mask:0xf bank_mask:0xf
  v_fmac_f32_dpp v26, v34, v23 quad_perm:[2,2,2,2] row_mask:0xf bank_mask:0xf
  v_fmac_f32_dpp v27, v35, v23 quad_perm:[3,3,3,3] row_mask:0xf bank_mask:0xf
  v_add_f32 v119, v24, v25
  v_add_f32 v120, v26, v27
  v_add_f32 v41, v119, v120
  v_mfma_f32_16x16x32_bf16 v[32:35], v[228:231], v[16:19], 0
  v_mul_f32_dpp v24, v28, v20 quad_perm:[0,0,0,0] row_mask:0xf bank_mask:0xf
  v_mul_f32_dpp v25, v29, v20 quad_perm:[1,1,1,1] row_mask:0xf bank_mask:0xf
  v_mul_f32_dpp v26, v30, v20 quad_perm:[2,2,2,2] row_mask:0xf bank_mask:0xf
  v_mul_f32_dpp v27, v31, v20 quad_perm:[3,3,3,3] row_mask:0xf bank_mask:0xf
  v_mfma_f32_16x16x32_bf16 v[28:31], v[232:235], v[16:19], 0
  s_nop 2
  v_fmac_f32_dpp v24, v32, v21 quad_perm:[0,0,0,0] row_mask:0xf bank_mask:0xf
  v_fmac_f32_dpp v25, v33, v21 quad_perm:[1,1,1,1] row_mask:0xf bank_mask:0xf
  v_fmac_f32_dpp v26, v34, v21 quad_perm:[2,2,2,2] row_mask:0xf bank_mask:0xf
  v_fmac_f32_dpp v27, v35, v21 quad_perm:[3,3,3,3] row_mask:0xf bank_mask:0xf
  v_mfma_f32_16x16x32_bf16 v[32:35], v[236:239], v[16:19], 0
  v_fmac_f32_dpp v24, v28, v22 quad_perm:[0,0,0,0] row_mask:0xf bank_mask:0xf
  v_fmac_f32_dpp v25, v29, v22 quad_perm:[1,1,1,1] row_mask:0xf bank_mask:0xf
  v_fmac_f32_dpp v26, v30, v22 quad_perm:[2,2,2,2] row_mask:0xf bank_mask:0xf
  v_fmac_f32_dpp v27, v31, v22 quad_perm:[3,3,3,3] row_mask:0xf bank_mask:0xf
  s_waitcnt vmcnt(2)
  buffer_load_dwordx4 v[128:131], v2, s[48:51], s88 offen offset:0 nt
  v_mfma_f32_16x16x32_bf16 v[28:31], v[240:243], v[16:19], 0
  s_nop 0
  v_fmac_f32_dpp v24, v32, v23 quad_perm:[0,0,0,0] row_mask:0xf bank_mask:0xf
  v_fmac_f32_dpp v25, v33, v23 quad_perm:[1,1,1,1] row_mask:0xf bank_mask:0xf
  v_fmac_f32_dpp v26, v34, v23 quad_perm:[2,2,2,2] row_mask:0xf bank_mask:0xf
  v_fmac_f32_dpp v27, v35, v23 quad_perm:[3,3,3,3] row_mask:0xf bank_mask:0xf
  v_add_f32 v119, v24, v25
  v_add_f32 v120, v26, v27
  v_add_f32 v42, v119, v120
  v_mfma_f32_16x16x32_bf16 v[32:35], v[244:247], v[16:19], 0
  v_mul_f32_dpp v24, v28, v20 quad_perm:[0,0,0,0] row_mask:0xf bank_mask:0xf
  v_mul_f32_dpp v25, v29, v20 quad_perm:[1,1,1,1] row_mask:0xf bank_mask:0xf
  v_mul_f32_dpp v26, v30, v20 quad_perm:[2,2,2,2] row_mask:0xf bank_mask:0xf
  v_mul_f32_dpp v27, v31, v20 quad_perm:[3,3,3,3] row_mask:0xf bank_mask:0xf
  s_waitcnt vmcnt(2)
  buffer_load_dwordx4 v[132:135], v2, s[48:51], s88 offen offset:1024 nt
  v_mfma_f32_16x16x32_bf16 v[28:31], v[248:251], v[16:19], 0
  s_nop 0
  v_fmac_f32_dpp v24, v32, v21 quad_perm:[0,0,0,0] row_mask:0xf bank_mask:0xf
  v_fmac_f32_dpp v25, v33, v21 quad_perm:[1,1,1,1] row_mask:0xf bank_mask:0xf
  v_fmac_f32_dpp v26, v34, v21 quad_perm:[2,2,2,2] row_mask:0xf bank_mask:0xf
  v_fmac_f32_dpp v27, v35, v21 quad_perm:[3,3,3,3] row_mask:0xf bank_mask:0xf
  s_waitcnt vmcnt(2)
  buffer_load_dwordx4 v[136:139], v2, s[48:51], s88 offen offset:2048 nt
  v_mfma_f32_16x16x32_bf16 v[32:35], v[252:255], v[16:19], 0
  v_fmac_f32_dpp v24, v28, v22 quad_perm:[0,0,0,0] row_mask:0xf bank_mask:0xf
  v_fmac_f32_dpp v25, v29, v22 quad_perm:[1,1,1,1] row_mask:0xf bank_mask:0xf
  v_fmac_f32_dpp v26, v30, v22 quad_perm:[2,2,2,2] row_mask:0xf bank_mask:0xf
  v_fmac_f32_dpp v27, v31, v22 quad_perm:[3,3,3,3] row_mask:0xf bank_mask:0xf
  s_waitcnt vmcnt(2)
  buffer_load_dwordx4 v[140:143], v2, s[48:51], s88 offen offset:3072 nt
  s_xor_b32 s88, s88, 32768
  s_nop 0
  v_fmac_f32_dpp v24, v32, v23 quad_perm:[0,0,0,0] row_mask:0xf bank_mask:0xf
  v_fmac_f32_dpp v25, v33, v23 quad_perm:[1,1,1,1] row_mask:0xf bank_mask:0xf
  v_fmac_f32_dpp v26, v34, v23 quad_perm:[2,2,2,2] row_mask:0xf bank_mask:0xf
  v_fmac_f32_dpp v27, v35, v23 quad_perm:[3,3,3,3] row_mask:0xf bank_mask:0xf
  v_add_f32 v119, v24, v25
  v_add_f32 v120, v26, v27
  v_add_f32 v43, v119, v120
  v_max3_f32 v64, v36, v37, v38
  v_max3_f32 v65, v39, v40, v41
  v_max3_f32 v64, v64, v42, v43
  v_max_f32 v15, v64, v65
  s_nop 1
  v_max_f32_dpp v15, v15, v15 quad_perm:[1,0,3,2] row_mask:0xf bank_mask:0xf
  s_nop 1
  v_max_f32_dpp v15, v15, v15 quad_perm:[2,3,0,1] row_mask:0xf bank_mask:0xf
  v_mov_b32 v64, v15
  s_nop 1
  v_permlane32_swap_b32 v15, v64
  v_max_f32 v15, v15, v64
  v_mov_b32 v64, v15
  s_nop 1
  v_permlane16_swap_b32 v15, v64
  v_max_f32 v15, v15, v64
  v_sub_f32 v36, v36, v15
  v_sub_f32 v37, v37, v15
  v_sub_f32 v38, v38, v15
  v_sub_f32 v39, v39, v15
  v_sub_f32 v40, v40, v15
  v_sub_f32 v41, v41, v15
  v_sub_f32 v42, v42, v15
  v_sub_f32 v43, v43, v15
  v_exp_f32 v36, v36
  v_exp_f32 v37, v37
  v_exp_f32 v38, v38
  v_exp_f32 v39, v39
  v_exp_f32 v40, v40
  v_exp_f32 v41, v41
  v_exp_f32 v42, v42
  v_exp_f32 v43, v43
  v_add_f32 v64, v36, v37
  v_add_f32 v65, v38, v39
  v_add_f32 v66, v40, v41
  v_add_f32 v67, v42, v43
  v_add_f32 v64, v64, v65
  v_add_f32 v66, v66, v67
  v_cvt_pk_bf16_f32 v36, v36, v36
  v_cvt_pk_bf16_f32 v37, v37, v37
  v_cvt_pk_bf16_f32 v38, v38, v38
  v_cvt_pk_bf16_f32 v39, v39, v39
  v_add_f32 v64, v64, v66
  v_cvt_pk_bf16_f32 v40, v40, v40
  v_cvt_pk_bf16_f32 v41, v41, v41
  v_cvt_pk_bf16_f32 v42, v42, v42
  v_cvt_pk_bf16_f32 v43, v43, v43
  v_add_f32_dpp v64, v64, v64 quad_perm:[1,0,3,2] row_mask:0xf bank_mask:0xf
  s_nop 1
  v_add_f32_dpp v64, v64, v64 quad_perm:[2,3,0,1] row_mask:0xf bank_mask:0xf
  v_mov_b32 v65, v64
  s_nop 1
  v_permlane32_swap_b32 v64, v65
  v_add_f32 v64, v64, v65
  v_mov_b32 v65, v64
  s_nop 1
  v_permlane16_swap_b32 v64, v65
  v_add_f32 v64, v64, v65
  s_lshl_b32 s3, s32, 2
  s_add_u32 s3, s3, 87808
  v_lshl_add_u32 v66, v7, 5, s3
  ds_write_b32 v66, v15
  ds_write_b32 v66, v64 offset:128
  s_waitcnt vmcnt(2)
  buffer_load_dwordx4 v[144:147], v2, s[48:51], s88 offen offset:0 nt
  v_and_b32 v119, 1, v8
  v_lshlrev_b32 v119, 1, v119
  v_lshrrev_b32 v72, 1, v8
  v_or_b32 v72, v72, v119
  s_lshr_b32 s3, s34, 4
  s_lshl_b32 s3, s3, 2
  v_add_u32 v72, s3, v72
  v_lshlrev_b32 v119, 2, v72
  v_add_u32 v104, 88064, v119
  v_mov_b32 v0, v118
  v_and_b32 v107, 0x7fff, v107
  s_mul_i32 s3, s32, 2080
  s_add_u32 s3, s3, 65536
  v_add_u32 v124, s3, v2
  s_lshr_b32 s3, s32, 1
  s_lshl_b32 s28, s3, 6
  s_lshl_b32 s3, s3, 2
  s_add_u32 s3, s3, 88096
  v_mov_b32 v111, s3
  s_and_b32 s3, s32, 1
  s_lshl_b32 s3, s3, 9
  s_add_u32 s3, s3, s28
  s_add_u32 s3, s3, 65536
  v_lshl_add_u32 v125, v6, 4, s3
  v_mul_u32_u24 v64, 4160, v7
  v_add_u32 v125, v64, v125
  v_lshrrev_b32 v64, 1, v8
  v_lshl_add_u32 v125, v64, 8, v125
  v_and_b32 v64, 1, v8
  v_lshl_add_u32 v125, v64, 10, v125
  s_lshl_b32 s3, s38, 13
  s_add_u32 s3, s3, 524288
  v_add_u32 v127, s3, v105
  s_lshl_b32 s3, s33, 3
  s_add_u32 s3, s3, s32
  s_lshl_b32 s3, s3, 13
  s_lshl_b32 s28, s34, 8
  s_add_u32 s3, s3, s28
  s_add_u32 s3, s3, 524288
  v_lshl_add_u32 v126, v6, 4, s3
  v_lshl_add_u32 v126, v8, 6, v126
  s_lshl_b32 s3, s36, 3
  s_add_u32 s3, s3, s81
  s_lshl_b32 s3, s3, 9
  s_mul_i32 s28, s38, 16384
  s_add_u32 s3, s3, s28
  s_add_u32 s3, s3, 1048576
  v_add_u32 v109, s3, v2
  s_lshl_b32 s3, s33, 2
  s_bfe_u32 s28, s34, 0x20002
  s_add_u32 s3, s3, s28
  s_lshl_b32 s3, s3, 9
  s_lshr_b32 s28, s34, 4
  s_lshl_b32 s28, s28, 8
  s_add_u32 s3, s3, s28
  s_lshl_b32 s28, s36, 6
  s_add_u32 s3, s3, s28
  s_mul_i32 s28, s81, 16384
  s_add_u32 s3, s3, s28
  s_add_u32 s3, s3, 1048576
  v_bfe_u32 v65, v1, 2, 3
  v_mul_u32_u24 v65, 131072, v65
  v_lshl_add_u32 v110, v6, 4, s3
  v_add_u32 v110, v110, v65
  v_lshrrev_b32 v65, 5, v1
  v_mul_u32_u24 v65, 16384, v65
  v_add_u32 v110, v110, v65
  s_lshl_b32 s3, s81, 9
  s_add_u32 s3, s3, 88160
  v_add_u32 v118, s3, v2
  v_add_u32 v108, 88160, v2
  s_and_b32 s3, s34, 15
  s_lshl_b32 s28, s33, 4
  s_add_u32 s3, s3, s28
  s_lshl_b32 s3, s3, 3
  v_lshl_add_u32 v117, v6, 1, s3
  v_lshl_add_u32 v117, v72, 10, v117
  s_waitcnt vmcnt(2)
  buffer_load_dwordx4 v[148:151], v2, s[48:51], s88 offen offset:1024 nt
  v_and_b32_dpp v60, v36, v4 quad_perm:[0,0,0,0] row_mask:0xf bank_mask:0xf
  v_and_b32_dpp v61, v36, v5 quad_perm:[0,0,0,0] row_mask:0xf bank_mask:0xf
  s_nop 1
  v_mfma_f32_16x16x16_bf16 v[44:47], v[128:129], v[60:61], 0
  v_mfma_f32_16x16x16_bf16 v[48:51], v[130:131], v[60:61], 0
  v_and_b32_dpp v62, v36, v4 quad_perm:[1,1,1,1] row_mask:0xf bank_mask:0xf
  v_and_b32_dpp v63, v36, v5 quad_perm:[1,1,1,1] row_mask:0xf bank_mask:0xf
  s_nop 1
  v_mfma_f32_16x16x16_bf16 v[44:47], v[132:133], v[62:63], v[44:47]
  v_mfma_f32_16x16x16_bf16 v[48:51], v[134:135], v[62:63], v[48:51]
  v_and_b32_dpp v60, v36, v4 quad_perm:[2,2,2,2] row_mask:0xf bank_mask:0xf
  v_and_b32_dpp v61, v36, v5 quad_perm:[2,2,2,2] row_mask:0xf bank_mask:0xf
  s_nop 1
  v_mfma_f32_16x16x16_bf16 v[44:47], v[136:137], v[60:61], v[44:47]
  v_mfma_f32_16x16x16_bf16 v[48:51], v[138:139], v[60:61], v[48:51]
  s_waitcnt vmcnt(2)
  buffer_load_dwordx4 v[152:155], v2, s[48:51], s88 offen offset:2048 nt
  v_and_b32_dpp v62, v36, v4 quad_perm:[3,3,3,3] row_mask:0xf bank_mask:0xf
  v_and_b32_dpp v63, v36, v5 quad_perm:[3,3,3,3] row_mask:0xf bank_mask:0xf
  s_nop 1
  v_mfma_f32_16x16x16_bf16 v[44:47], v[140:141], v[62:63], v[44:47]
  v_mfma_f32_16x16x16_bf16 v[48:51], v[142:143], v[62:63], v[48:51]
  s_waitcnt vmcnt(2)
  buffer_load_dwordx4 v[156:159], v2, s[48:51], s88 offen offset:3072 nt
  s_xor_b32 s88, s88, 98304
  s_cmp_lg_u32 s32, 2
  s_cbranch_scc1 L_norl
  global_load_dword v121, v0, s[30:31] offset:128 sc1
L_norl:
  s_cmp_lg_u32 s32, 1
  s_cbranch_scc1 L_novl
  v_lshlrev_b32 v18, 3, v6
  v_add_u32 v18, 8192, v18
  global_load_dwordx2 v[16:17], v18, s[30:31] sc1
L_novl:
  buffer_load_dwordx4 v[56:59], v105, s[72:75], 0 offen sc1
  v_and_b32_dpp v60, v37, v4 quad_perm:[0,0,0,0] row_mask:0xf bank_mask:0xf
  v_and_b32_dpp v61, v37, v5 quad_perm:[0,0,0,0] row_mask:0xf bank_mask:0xf
  s_nop 1
  v_mfma_f32_16x16x16_bf16 v[44:47], v[144:145], v[60:61], v[44:47]
  v_mfma_f32_16x16x16_bf16 v[48:51], v[146:147], v[60:61], v[48:51]
  s_waitcnt vmcnt(3)
  buffer_load_dwordx4 v[160:163], v2, s[48:51], s88 offen offset:0 nt
  v_and_b32_dpp v62, v37, v4 quad_perm:[1,1,1,1] row_mask:0xf bank_mask:0xf
  v_and_b32_dpp v63, v37, v5 quad_perm:[1,1,1,1] row_mask:0xf bank_mask:0xf
  s_nop 1
  v_mfma_f32_16x16x16_bf16 v[44:47], v[148:149], v[62:63], v[44:47]
  v_mfma_f32_16x16x16_bf16 v[48:51], v[150:151], v[62:63], v[48:51]
  s_waitcnt vmcnt(3)
  buffer_load_dwordx4 v[164:167], v2, s[48:51], s88 offen offset:1024 nt
  v_and_b32_dpp v60, v37, v4 quad_perm:[2,2,2,2] row_mask:0xf bank_mask:0xf
  v_and_b32_dpp v61, v37, v5 quad_perm:[2,2,2,2] row_mask:0xf bank_mask:0xf
  s_nop 1
  v_mfma_f32_16x16x16_bf16 v[44:47], v[152:153], v[60:61], v[44:47]
  v_mfma_f32_16x16x16_bf16 v[48:51], v[154:155], v[60:61], v[48:51]
  s_waitcnt vmcnt(3)
  buffer_load_dwordx4 v[168:171], v2, s[48:51], s88 offen offset:2048 nt
  v_and_b32_dpp v62, v37, v4 quad_perm:[3,3,3,3] row_mask:0xf bank_mask:0xf
  v_and_b32_dpp v63, v37, v5 quad_perm:[3,3,3,3] row_mask:0xf bank_mask:0xf
  s_nop 1
  v_mfma_f32_16x16x16_bf16 v[44:47], v[156:157], v[62:63], v[44:47]
  v_mfma_f32_16x16x16_bf16 v[48:51], v[158:159], v[62:63], v[48:51]
  s_waitcnt vmcnt(2)
  buffer_load_dwordx4 v[172:175], v2, s[48:51], s88 offen offset:3072 nt
  s_xor_b32 s88, s88, 32768
  s_cmp_lg_u32 s32, 2
  s_cbranch_scc1 L_c_ok
  s_mov_b32 s3, 4000000
L_c_chk:
  v_cmp_ne_u32 vcc, s37, v121
  s_cbranch_vccz L_c_ok
  s_sub_u32 s3, s3, 1
  s_cbranch_scc1 L_c_ok
  global_load_dword v121, v0, s[30:31] offset:128 sc1
  s_waitcnt vmcnt(0)
  s_branch L_c_chk
L_c_ok:
  s_cmp_lg_u32 s32, 1
  s_cbranch_scc1 L_v_done
  s_mov_b32 s3, 4000000
L_v_chk:
  v_cmp_ne_u32 vcc, s37, v16
  s_cbranch_vccz L_v_ok
  s_sub_u32 s3, s3, 1
  s_cbranch_scc1 L_v_ok
  global_load_dwordx2 v[16:17], v18, s[30:31] sc1
  s_waitcnt vmcnt(0)
  s_branch L_v_chk
L_v_ok:
  v_add_u32_dpp v17, v17, v17 quad_perm:[1,0,3,2] row_mask:0xf bank_mask:0xf
  s_nop 1
  v_add_u32_dpp v17, v17, v17 quad_perm:[2,3,0,1] row_mask:0xf bank_mask:0xf
  v_sub_u32 v17, 0, v17
  v_lshrrev_b32 v17, 31, v17
  v_lshlrev_b32 v17, 13, v17
  v_mov_b32 v16, 88128
  ds_write_b32 v16, v17
L_v_done:
  s_mov_b32 s3, 4000000
L_h_chk:
  v_perm_b32 v64, v57, v56, s14
  v_perm_b32 v65, v59, v58, s14
  v_perm_b32 v64, v65, v64, s15
  v_cmp_ne_u32 vcc, s41, v64
  s_cbranch_vccz L_h_ok
  s_sub_u32 s3, s3, 1
  s_cbranch_scc1 L_h_ok
  buffer_load_dwordx4 v[56:59], v105, s[72:75], 0 offen sc1
  s_waitcnt vmcnt(0)
  s_branch L_h_chk
L_h_ok:
  v_and_b32 v56, s42, v56
  v_and_b32 v57, s42, v57
  v_and_b32 v58, s42, v58
  v_and_b32 v59, s42, v59
  v_add_f32_dpp v56, v56, v56 row_ror:8 row_mask:0xf bank_mask:0xf
  v_add_f32_dpp v57, v57, v57 row_ror:8 row_mask:0xf bank_mask:0xf
  v_add_f32_dpp v58, v58, v58 row_ror:8 row_mask:0xf bank_mask:0xf
  v_add_f32_dpp v59, v59, v59 row_ror:8 row_mask:0xf bank_mask:0xf
  v_add_f32_dpp v56, v56, v56 row_ror:4 row_mask:0xf bank_mask:0xf
  v_add_f32_dpp v57, v57, v57 row_ror:4 row_mask:0xf bank_mask:0xf
  v_add_f32_dpp v58, v58, v58 row_ror:4 row_mask:0xf bank_mask:0xf
  v_add_f32_dpp v59, v59, v59 row_ror:4 row_mask:0xf bank_mask:0xf
  v_lshlrev_b32 v64, 16, v122
  v_and_b32 v65, 0xffff0000, v122
  v_lshlrev_b32 v66, 16, v123
  v_and_b32 v67, 0xffff0000, v123
  v_mov_b32 v68, 0xc0135761
  v_sub_f32 v69, 1.0, v13
  v_add_f32 v56, v56, v64
  v_add_f32 v57, v57, v65
  v_add_f32 v58, v58, v66
  v_add_f32 v59, v59, v67
  v_mul_f32 v72, v56, v56
  v_mul_f32 v73, v57, v57
  v_mul_f32 v74, v58, v58
  v_mul_f32 v75, v59, v59
  v_fmamk_f32 v72, v72, 0xbdd2d3e8, v68
  v_fmamk_f32 v73, v73, 0xbdd2d3e8, v68
  v_fmamk_f32 v74, v74, 0xbdd2d3e8, v68
  v_fmamk_f32 v75, v75, 0xbdd2d3e8, v68
  v_mul_f32 v72, v72, v56
  v_mul_f32 v73, v73, v57
  v_mul_f32 v74, v74, v58
  v_mul_f32 v75, v75, v59
  v_exp_f32 v72, v72
  v_exp_f32 v73, v73
  v_exp_f32 v74, v74
  v_exp_f32 v75, v75
  v_add_f32 v72, 1.0, v72
  v_add_f32 v73, 1.0, v73
  v_add_f32 v74, 1.0, v74
  v_add_f32 v75, 1.0, v75
  v_rcp_f32 v72, v72
  v_rcp_f32 v73, v73
  v_rcp_f32 v74, v74
  v_rcp_f32 v75, v75
  v_mul_f32 v56, v56, v69
  v_mul_f32 v57, v57, v69
  v_mul_f32 v58, v58, v69
  v_mul_f32 v59, v59, v69
  v_mul_f32 v56, v56, v72
  v_mul_f32 v57, v57, v73
  v_mul_f32 v58, v58, v74
  v_mul_f32 v59, v59, v75
  v_cvt_pk_bf16_f32 v56, v56, v57
  v_cvt_pk_bf16_f32 v57, v58, v59
  ds_write_b64 v112, v[56:57]
  s_waitcnt vmcnt(2)
  buffer_load_dwordx4 v[176:179], v2, s[48:51], s88 offen offset:0 nt
  v_and_b32_dpp v60, v38, v4 quad_perm:[0,0,0,0] row_mask:0xf bank_mask:0xf
  v_and_b32_dpp v61, v38, v5 quad_perm:[0,0,0,0] row_mask:0xf bank_mask:0xf
  s_nop 1
  v_mfma_f32_16x16x16_bf16 v[44:47], v[160:161], v[60:61], v[44:47]
  v_mfma_f32_16x16x16_bf16 v[48:51], v[162:163], v[60:61], v[48:51]
  v_and_b32_dpp v62, v38, v4 quad_perm:[1,1,1,1] row_mask:0xf bank_mask:0xf
  v_and_b32_dpp v63, v38, v5 quad_perm:[1,1,1,1] row_mask:0xf bank_mask:0xf
  s_nop 1
  v_mfma_f32_16x16x16_bf16 v[44:47], v[164:165], v[62:63], v[44:47]
  v_mfma_f32_16x16x16_bf16 v[48:51], v[166:167], v[62:63], v[48:51]
  s_waitcnt vmcnt(2)
  buffer_load_dwordx4 v[180:183], v2, s[48:51], s88 offen offset:1024 nt
  v_and_b32_dpp v60, v38, v4 quad_perm:[2,2,2,2] row_mask:0xf bank_mask:0xf
  v_and_b32_dpp v61, v38, v5 quad_perm:[2,2,2,2] row_mask:0xf bank_mask:0xf
  s_nop 1
  v_mfma_f32_16x16x16_bf16 v[44:47], v[168:169], v[60:61], v[44:47]
  v_mfma_f32_16x16x16_bf16 v[48:51], v[170:171], v[60:61], v[48:51]
  s_waitcnt vmcnt(2)
  buffer_load_dwordx4 v[184:187], v2, s[48:51], s88 offen offset:2048 nt
  v_xor_b32 v122, 32, v115
  v_xor_b32 v123, 32, v114
  s_waitcnt lgkmcnt(0)
  s_barrier
  v_lshlrev_b32 v119, 5, v7
  v_add_u32 v119, 87808, v119
  ds_read_b128 v[64:67], v119
  ds_read_b128 v[68:71], v119 offset:16
  ds_read_b128 v[72:75], v119 offset:128
  ds_read_b128 v[76:79], v119 offset:144
  ds_read_b128 v[28:31], v113
  ds_read_b128 v[32:35], v113 offset:64
  ds_read_b32 v88, v104
  v_mov_b32 v89, 88128
  ds_read_b32 v89, v89
  s_waitcnt lgkmcnt(4)
  ds_read_b64_tr_b16 v[96:97], v115 offset:49152
  ds_read_b64_tr_b16 v[98:99], v115 offset:50176
  ds_read_b64_tr_b16 v[100:101], v115 offset:57344
  ds_read_b64_tr_b16 v[102:103], v115 offset:58368
  ds_read_b64_tr_b16 v[16:17], v122 offset:49152
  ds_read_b64_tr_b16 v[18:19], v122 offset:50176
  ds_read_b64_tr_b16 v[20:21], v122 offset:57344
  ds_read_b64_tr_b16 v[22:23], v122 offset:58368
  s_waitcnt lgkmcnt(0)
  v_mfma_f32_16x16x32_bf16 v[52:55], v[28:31], v[96:99], 0
  v_mfma_f32_16x16x32_bf16 v[52:55], v[32:35], v[100:103], v[52:55]
  v_mfma_f32_16x16x32_bf16 v[24:27], v[28:31], v[16:19], 0
  v_mfma_f32_16x16x32_bf16 v[24:27], v[32:35], v[20:23], v[24:27]
  v_xor_b32 v109, v89, v109
  v_xor_b32 v110, v89, v110
  v_max3_f32 v120, v64, v65, v66
  v_max3_f32 v120, v120, v67, v68
  v_max3_f32 v120, v120, v69, v70
  v_max_f32 v120, v120, v71
  v_sub_f32 v64, v64, v120
  v_sub_f32 v65, v65, v120
  v_sub_f32 v66, v66, v120
  v_sub_f32 v67, v67, v120
  v_sub_f32 v68, v68, v120
  v_sub_f32 v69, v69, v120
  v_sub_f32 v70, v70, v120
  v_sub_f32 v71, v71, v120
  v_sub_f32 v14, v15, v120
  v_exp_f32 v64, v64
  v_exp_f32 v65, v65
  v_exp_f32 v66, v66
  v_exp_f32 v67, v67
  v_exp_f32 v68, v68
  v_exp_f32 v69, v69
  v_exp_f32 v70, v70
  v_exp_f32 v71, v71
  v_exp_f32 v14, v14
  v_mul_f32 v64, v64, v72
  v_fmac_f32 v64, v65, v73
  v_fmac_f32 v64, v66, v74
  v_fmac_f32 v64, v67, v75
  v_fmac_f32 v64, v68, v76
  v_fmac_f32 v64, v69, v77
  v_fmac_f32 v64, v70, v78
  v_fmac_f32 v64, v71, v79
  v_rcp_f32 v65, v64
  v_log_f32 v66, v64
  v_mul_f32 v14, v14, v65
  v_add_f32 v66, v66, v120
  v_lshlrev_b32 v67, 2, v7
  v_add_u32 v67, 88096, v67
  ds_write_b32 v67, v66
  v_sub_f32 v88, 1.0, v88
  v_lshlrev_b32 v116, 16, v116
  v_mul_f32 v116, v116, v88
  s_waitcnt vmcnt(2)
  buffer_load_dwordx4 v[188:191], v2, s[48:51], s88 offen offset:3072 nt
  s_xor_b32 s88, s88, 229376
  v_and_b32_dpp v62, v38, v4 quad_perm:[3,3,3,3] row_mask:0xf bank_mask:0xf
  v_and_b32_dpp v63, v38, v5 quad_perm:[3,3,3,3] row_mask:0xf bank_mask:0xf
  s_nop 1
  v_mfma_f32_16x16x16_bf16 v[44:47], v[172:173], v[62:63], v[44:47]
  v_mfma_f32_16x16x16_bf16 v[48:51], v[174:175], v[62:63], v[48:51]
  v_and_b32_dpp v60, v39, v4 quad_perm:[0,0,0,0] row_mask:0xf bank_mask:0xf
  v_and_b32_dpp v61, v39, v5 quad_perm:[0,0,0,0] row_mask:0xf bank_mask:0xf
  s_nop 1
  v_mfma_f32_16x16x16_bf16 v[44:47], v[176:177], v[60:61], v[44:47]
  v_mfma_f32_16x16x16_bf16 v[48:51], v[178:179], v[60:61], v[48:51]
  s_waitcnt vmcnt(2)
  buffer_load_dwordx4 v[192:195], v2, s[48:51], s88 offen offset:0 nt
  v_and_b32_dpp v62, v39, v4 quad_perm:[1,1,1,1] row_mask:0xf bank_mask:0xf
  v_and_b32_dpp v63, v39, v5 quad_perm:[1,1,1,1] row_mask:0xf bank_mask:0xf
  s_nop 1
  v_mfma_f32_16x16x16_bf16 v[44:47], v[180:181], v[62:63], v[44:47]
  v_mfma_f32_16x16x16_bf16 v[48:51], v[182:183], v[62:63], v[48:51]
  s_waitcnt vmcnt(2)
  buffer_load_dwordx4 v[196:199], v2, s[48:51], s88 offen offset:1024 nt
  v_and_b32_dpp v60, v39, v4 quad_perm:[2,2,2,2] row_mask:0xf bank_mask:0xf
  v_and_b32_dpp v61, v39, v5 quad_perm:[2,2,2,2] row_mask:0xf bank_mask:0xf
  s_nop 1
  v_mfma_f32_16x16x16_bf16 v[44:47], v[184:185], v[60:61], v[44:47]
  v_mfma_f32_16x16x16_bf16 v[48:51], v[186:187], v[60:61], v[48:51]
  s_waitcnt vmcnt(2)
  buffer_load_dwordx4 v[200:203], v2, s[48:51], s88 offen offset:2048 nt
  v_and_b32_dpp v62, v39, v4 quad_perm:[3,3,3,3] row_mask:0xf bank_mask:0xf
  v_and_b32_dpp v63, v39, v5 quad_perm:[3,3,3,3] row_mask:0xf bank_mask:0xf
  s_nop 1
  v_mfma_f32_16x16x16_bf16 v[44:47], v[188:189], v[62:63], v[44:47]
  v_mfma_f32_16x16x16_bf16 v[48:51], v[190:191], v[62:63], v[48:51]
  s_waitcnt vmcnt(2)
  buffer_load_dwordx4 v[204:207], v2, s[48:51], s88 offen offset:3072 nt
  s_xor_b32 s88, s88, 32768
  v_and_b32_dpp v60, v40, v4 quad_perm:[0,0,0,0] row_mask:0xf bank_mask:0xf
  v_and_b32_dpp v61, v40, v5 quad_perm:[0,0,0,0] row_mask:0xf bank_mask:0xf
  s_nop 1
  v_mfma_f32_16x16x16_bf16 v[44:47], v[192:193], v[60:61], v[44:47]
  v_mfma_f32_16x16x16_bf16 v[48:51], v[194:195], v[60:61], v[48:51]
  s_waitcnt vmcnt(2)
  buffer_load_dwordx4 v[208:211], v2, s[48:51], s88 offen offset:0 nt
  v_and_b32_dpp v62, v40, v4 quad_perm:[1,1,1,1] row_mask:0xf bank_mask:0xf
  v_and_b32_dpp v63, v40, v5 quad_perm:[1,1,1,1] row_mask:0xf bank_mask:0xf
  s_nop 1
  v_mfma_f32_16x16x16_bf16 v[44:47], v[196:197], v[62:63], v[44:47]
  v_mfma_f32_16x16x16_bf16 v[48:51], v[198:199], v[62:63], v[48:51]
  s_waitcnt vmcnt(2)
  buffer_load_dwordx4 v[212:215], v2, s[48:51], s88 offen offset:1024 nt
  v_and_b32_dpp v60, v40, v4 quad_perm:[2,2,2,2] row_mask:0xf bank_mask:0xf
  v_and_b32_dpp v61, v40, v5 quad_perm:[2,2,2,2] row_mask:0xf bank_mask:0xf
  s_nop 1
  v_mfma_f32_16x16x16_bf16 v[44:47], v[200:201], v[60:61], v[44:47]
  v_mfma_f32_16x16x16_bf16 v[48:51], v[202:203], v[60:61], v[48:51]
  s_waitcnt vmcnt(2)
  buffer_load_dwordx4 v[216:219], v2, s[48:51], s88 offen offset:2048 nt
  v_and_b32_dpp v62, v40, v4 quad_perm:[3,3,3,3] row_mask:0xf bank_mask:0xf
  v_and_b32_dpp v63, v40, v5 quad_perm:[3,3,3,3] row_mask:0xf bank_mask:0xf
  s_nop 1
  v_mfma_f32_16x16x16_bf16 v[44:47], v[204:205], v[62:63], v[44:47]
  v_mfma_f32_16x16x16_bf16 v[48:51], v[206:207], v[62:63], v[48:51]
  s_waitcnt vmcnt(2)
  buffer_load_dwordx4 v[220:223], v2, s[48:51], s88 offen offset:3072 nt
  s_xor_b32 s88, s88, 98304
  v_and_b32_dpp v60, v41, v4 quad_perm:[0,0,0,0] row_mask:0xf bank_mask:0xf
  v_and_b32_dpp v61, v41, v5 quad_perm:[0,0,0,0] row_mask:0xf bank_mask:0xf
  s_nop 1
  v_mfma_f32_16x16x16_bf16 v[44:47], v[208:209], v[60:61], v[44:47]
  v_mfma_f32_16x16x16_bf16 v[48:51], v[210:211], v[60:61], v[48:51]
  s_waitcnt vmcnt(2)
  buffer_load_dwordx4 v[224:227], v2, s[48:51], s88 offen offset:0 nt
  v_and_b32_dpp v62, v41, v4 quad_perm:[1,1,1,1] row_mask:0xf bank_mask:0xf
  v_and_b32_dpp v63, v41, v5 quad_perm:[1,1,1,1] row_mask:0xf bank_mask:0xf
  s_nop 1
  v_mfma_f32_16x16x16_bf16 v[44:47], v[212:213], v[62:63], v[44:47]
  v_mfma_f32_16x16x16_bf16 v[48:51], v[214:215], v[62:63], v[48:51]
  s_waitcnt vmcnt(2)
  buffer_load_dwordx4 v[228:231], v2, s[48:51], s88 offen offset:1024 nt
  v_and_b32_dpp v60, v41, v4 quad_perm:[2,2,2,2] row_mask:0xf bank_mask:0xf
  v_and_b32_dpp v61, v41, v5 quad_perm:[2,2,2,2] row_mask:0xf bank_mask:0xf
  s_nop 1
  v_mfma_f32_16x16x16_bf16 v[44:47], v[216:217], v[60:61], v[44:47]
  v_mfma_f32_16x16x16_bf16 v[48:51], v[218:219], v[60:61], v[48:51]
  buffer_load_dwordx4 v[232:235], v2, s[48:51], s88 offen offset:2048 nt
  buffer_load_dwordx4 v[236:239], v2, s[48:51], s88 offen offset:3072 nt
  s_xor_b32 s88, s88, 32768
  buffer_load_dwordx4 v[240:243], v2, s[48:51], s88 offen offset:0 nt
  s_waitcnt vmcnt(5)
  buffer_load_dwordx4 v[244:247], v2, s[48:51], s88 offen offset:1024 nt
  v_and_b32_dpp v62, v41, v4 quad_perm:[3,3,3,3] row_mask:0xf bank_mask:0xf
  v_and_b32_dpp v63, v41, v5 quad_perm:[3,3,3,3] row_mask:0xf bank_mask:0xf
  s_nop 1
  v_mfma_f32_16x16x16_bf16 v[44:47], v[220:221], v[62:63], v[44:47]
  v_mfma_f32_16x16x16_bf16 v[48:51], v[222:223], v[62:63], v[48:51]
  s_waitcnt vmcnt(5)
  buffer_load_dwordx4 v[248:251], v2, s[48:51], s88 offen offset:2048 nt
  v_and_b32_dpp v60, v42, v4 quad_perm:[0,0,0,0] row_mask:0xf bank_mask:0xf
  v_and_b32_dpp v61, v42, v5 quad_perm:[0,0,0,0] row_mask:0xf bank_mask:0xf
  s_nop 1
  v_mfma_f32_16x16x16_bf16 v[44:47], v[224:225], v[60:61], v[44:47]
  v_mfma_f32_16x16x16_bf16 v[48:51], v[226:227], v[60:61], v[48:51]
  s_waitcnt vmcnt(5)
  buffer_load_dwordx4 v[252:255], v2, s[48:51], s88 offen offset:3072 nt
  v_and_b32_dpp v62, v42, v4 quad_perm:[1,1,1,1] row_mask:0xf bank_mask:0xf
  v_and_b32_dpp v63, v42, v5 quad_perm:[1,1,1,1] row_mask:0xf bank_mask:0xf
  s_nop 1
  v_mfma_f32_16x16x16_bf16 v[44:47], v[228:229], v[62:63], v[44:47]
  v_mfma_f32_16x16x16_bf16 v[48:51], v[230:231], v[62:63], v[48:51]
  v_mov_b32 v67, s80
  v_and_b32_dpp v60, v42, v4 quad_perm:[2,2,2,2] row_mask:0xf bank_mask:0xf
  v_and_b32_dpp v61, v42, v5 quad_perm:[2,2,2,2] row_mask:0xf bank_mask:0xf
  s_waitcnt vmcnt(5)
  s_nop 0
  v_mfma_f32_16x16x16_bf16 v[44:47], v[232:233], v[60:61], v[44:47]
  v_mfma_f32_16x16x16_bf16 v[48:51], v[234:235], v[60:61], v[48:51]
  v_and_b32_dpp v62, v42, v4 quad_perm:[3,3,3,3] row_mask:0xf bank_mask:0xf
  v_and_b32_dpp v63, v42, v5 quad_perm:[3,3,3,3] row_mask:0xf bank_mask:0xf
  s_waitcnt vmcnt(4)
  s_nop 0
  v_mfma_f32_16x16x16_bf16 v[44:47], v[236:237], v[62:63], v[44:47]
  v_mfma_f32_16x16x16_bf16 v[48:51], v[238:239], v[62:63], v[48:51]
  v_and_b32_dpp v60, v43, v4 quad_perm:[0,0,0,0] row_mask:0xf bank_mask:0xf
  v_and_b32_dpp v61, v43, v5 quad_perm:[0,0,0,0] row_mask:0xf bank_mask:0xf
  s_waitcnt vmcnt(3)
  s_nop 0
  v_mfma_f32_16x16x16_bf16 v[44:47], v[240:241], v[60:61], v[44:47]
  v_mfma_f32_16x16x16_bf16 v[48:51], v[242:243], v[60:61], v[48:51]
  v_and_b32_dpp v62, v43, v4 quad_perm:[1,1,1,1] row_mask:0xf bank_mask:0xf
  v_and_b32_dpp v63, v43, v5 quad_perm:[1,1,1,1] row_mask:0xf bank_mask:0xf
  s_waitcnt vmcnt(2)
  s_nop 0
  v_mfma_f32_16x16x16_bf16 v[44:47], v[244:245], v[62:63], v[44:47]
  v_mfma_f32_16x16x16_bf16 v[48:51], v[246:247], v[62:63], v[48:51]
  v_and_b32_dpp v60, v43, v4 quad_perm:[2,2,2,2] row_mask:0xf bank_mask:0xf
  v_and_b32_dpp v61, v43, v5 quad_perm:[2,2,2,2] row_mask:0xf bank_mask:0xf
  s_waitcnt vmcnt(1)
  s_nop 0
  v_mfma_f32_16x16x16_bf16 v[44:47], v[248:249], v[60:61], v[44:47]
  v_mfma_f32_16x16x16_bf16 v[48:51], v[250:251], v[60:61], v[48:51]
  v_and_b32_dpp v62, v43, v4 quad_perm:[3,3,3,3] row_mask:0xf bank_mask:0xf
  v_and_b32_dpp v63, v43, v5 quad_perm:[3,3,3,3] row_mask:0xf bank_mask:0xf
  s_waitcnt vmcnt(0)
  s_nop 0
  v_mfma_f32_16x16x16_bf16 v[44:47], v[252:253], v[62:63], v[44:47]
  v_mfma_f32_16x16x16_bf16 v[48:51], v[254:255], v[62:63], v[48:51]
  s_cmp_gt_u32 s32, 3
  s_cbranch_scc1 L_nolate
  s_lshl_b32 s28, s81, 10
  s_add_u32 m0, s28, 32768
  s_mov_b32 s3, 0
  buffer_load_dwordx4 v107, s[60:63], s3 offen nt lds
  s_add_u32 m0, s28, 33792
  s_mov_b32 s3, 4096
  buffer_load_dwordx4 v107, s[60:63], s3 offen nt lds
  s_add_u32 m0, s28, 40960
  s_mov_b32 s3, 32768
  buffer_load_dwordx4 v107, s[60:63], s3 offen nt lds
  s_add_u32 m0, s28, 41984
  s_mov_b32 s3, 36864
  buffer_load_dwordx4 v107, s[60:63], s3 offen nt lds
L_nolate:
  s_nop 5
  v_mul_f32 v44, v44, v14
  v_mul_f32 v45, v45, v14
  v_mul_f32 v46, v46, v14
  v_mul_f32 v47, v47, v14
  v_mul_f32 v48, v48, v14
  v_mul_f32 v49, v49, v14
  v_mul_f32 v50, v50, v14
  v_mul_f32 v51, v51, v14
  ds_write_b128 v124, v[44:47]
  ds_write_b128 v124, v[48:51] offset:1024
  s_waitcnt lgkmcnt(0)
  s_barrier
  ds_read_b128 v[80:83], v125
  ds_read_b128 v[84:87], v125 offset:2080
  ds_read_b32 v66, v111
  s_cmp_eq_u32 s82, 0
  s_waitcnt lgkmcnt(1)
  v_add_f32 v80, v80, v84
  v_add_f32 v81, v81, v85
  v_add_f32 v82, v82, v86
  v_add_f32 v83, v83, v87
  v_add_f32_dpp v80, v80, v80 row_ror:8 row_mask:0xf bank_mask:0xf
  v_add_f32_dpp v81, v81, v81 row_ror:8 row_mask:0xf bank_mask:0xf
  v_add_f32_dpp v82, v82, v82 row_ror:8 row_mask:0xf bank_mask:0xf
  v_add_f32_dpp v83, v83, v83 row_ror:8 row_mask:0xf bank_mask:0xf
  v_add_f32_dpp v80, v80, v80 row_ror:4 row_mask:0xf bank_mask:0xf
  v_add_f32_dpp v81, v81, v81 row_ror:4 row_mask:0xf bank_mask:0xf
  v_add_f32_dpp v82, v82, v82 row_ror:4 row_mask:0xf bank_mask:0xf
  v_add_f32_dpp v83, v83, v83 row_ror:4 row_mask:0xf bank_mask:0xf
  v_cvt_pk_bf16_f32 v64, v80, v81
  v_cvt_pk_bf16_f32 v65, v82, v83
  s_mov_b32 exec_lo, 0x000f000f
  s_mov_b32 exec_hi, 0x000f000f
  s_waitcnt lgkmcnt(0)
  s_cbranch_scc0 L_og_glob
  global_store_dwordx4 v126, v[64:67], s[30:31]
L_og_done:
  s_mov_b64 exec, -1
  global_load_dwordx4 v[56:59], v127, s[30:31] sc1
  s_mov_b32 s3, 4000000
  s_waitcnt vmcnt(0)
L_o_chk:
  v_cmp_ne_u32 vcc, s80, v59
  s_cbranch_vccz L_o_ok
  s_sub_u32 s3, s3, 1
  s_cbranch_scc1 L_o_ok
  s_mov_b64 exec, vcc
  global_load_dwordx4 v[56:59], v127, s[30:31] sc1
  s_mov_b64 exec, -1
  s_waitcnt vmcnt(0)
  s_branch L_o_chk
L_og_glob:
  global_store_dwordx4 v126, v[64:67], s[30:31] sc1
  s_branch L_og_done
L_o_ok:
  v_max_f32_dpp v72, v58, v58 row_ror:8 row_mask:0xf bank_mask:0xf
  v_lshlrev_b32 v76, 16, v56
  v_and_b32 v77, 0xffff0000, v56
  v_max_f32_dpp v73, v72, v72 row_ror:4 row_mask:0xf bank_mask:0xf
  v_lshlrev_b32 v78, 16, v57
  v_sub_f32 v73, v58, v73
  v_exp_f32 v73, v73
  v_and_b32 v79, 0xffff0000, v57
  v_mul_f32 v76, v76, v73
  v_mul_f32 v77, v77, v73
  v_add_f32_dpp v72, v73, v73 row_ror:8 row_mask:0xf bank_mask:0xf
  v_mul_f32 v78, v78, v73
  v_mul_f32 v79, v79, v73
  v_add_f32_dpp v74, v72, v72 row_ror:4 row_mask:0xf bank_mask:0xf
  v_add_f32_dpp v76, v76, v76 row_ror:8 row_mask:0xf bank_mask:0xf
  v_rcp_f32 v74, v74
  v_add_f32_dpp v77, v77, v77 row_ror:8 row_mask:0xf bank_mask:0xf
  v_add_f32_dpp v78, v78, v78 row_ror:8 row_mask:0xf bank_mask:0xf
  v_add_f32_dpp v79, v79, v79 row_ror:8 row_mask:0xf bank_mask:0xf
  v_mul_f32 v74, v74, v13
  v_add_f32_dpp v76, v76, v76 row_ror:4 row_mask:0xf bank_mask:0xf
  v_add_f32_dpp v77, v77, v77 row_ror:4 row_mask:0xf bank_mask:0xf
  v_add_f32_dpp v78, v78, v78 row_ror:4 row_mask:0xf bank_mask:0xf
  v_add_f32_dpp v79, v79, v79 row_ror:4 row_mask:0xf bank_mask:0xf
  v_mul_f32 v76, v76, v74
  v_mul_f32 v77, v77, v74
  v_mul_f32 v78, v78, v74
  v_mul_f32 v79, v79, v74
  v_cvt_pk_bf16_f32 v72, v76, v77
  v_cvt_pk_bf16_f32 v73, v78, v79
  ds_write_b64 v112, v[72:73] offset:1280
  s_cmp_gt_u32 s32, 3
  s_waitcnt lgkmcnt(0)
  s_barrier
  s_cbranch_scc1 L_poll
  ds_read_b128 v[80:83], v113 offset:1280
  ds_read_b128 v[84:87], v113 offset:1344
  ds_read_b64_tr_b16 v[96:97], v114 offset:32768
  ds_read_b64_tr_b16 v[98:99], v114 offset:33024
  ds_read_b64_tr_b16 v[16:17], v123 offset:32768
  ds_read_b64_tr_b16 v[18:19], v123 offset:33024
  ds_read_b64_tr_b16 v[100:101], v114 offset:40960
  ds_read_b64_tr_b16 v[102:103], v114 offset:41216
  ds_read_b64_tr_b16 v[20:21], v123 offset:40960
  ds_read_b64_tr_b16 v[22:23], v123 offset:41216
  s_waitcnt lgkmcnt(4)
  v_mfma_f32_16x16x32_bf16 v[52:55], v[80:83], v[96:99], v[52:55]
  v_mfma_f32_16x16x32_bf16 v[24:27], v[80:83], v[16:19], v[24:27]
  s_waitcnt lgkmcnt(0)
  v_mfma_f32_16x16x32_bf16 v[52:55], v[84:87], v[100:103], v[52:55]
  v_mfma_f32_16x16x32_bf16 v[24:27], v[84:87], v[20:23], v[24:27]
  s_nop 6
  v_and_or_b32 v52, v52, s42, v9
  v_and_or_b32 v53, v53, s42, v10
  v_and_or_b32 v54, v54, s42, v11
  v_and_or_b32 v55, v55, s42, v12
  s_mov_b32 exec_lo, 0
  v_and_or_b32 v52, v24, s42, v9
  v_and_or_b32 v53, v25, s42, v10
  v_and_or_b32 v54, v26, s42, v11
  v_and_or_b32 v55, v27, s42, v12
  s_mov_b32 exec_lo, -1
  global_store_dwordx4 v109, v[52:55], s[30:31] sc1
  s_waitcnt vmcnt(0)
  s_barrier
  s_barrier
  s_endpgm
L_poll:
  s_barrier
  global_load_dwordx4 v[56:59], v110, s[30:31] sc1
  s_mov_b32 s3, 4000000
  s_waitcnt vmcnt(0)
L_p_chk:
  v_perm_b32 v72, v57, v56, s14
  v_perm_b32 v73, v59, v58, s14
  v_perm_b32 v72, v73, v72, s15
  v_cmp_ne_u32 vcc, s37, v72
  s_cbranch_vccz L_p_ok
  s_sub_u32 s3, s3, 1
  s_cbranch_scc1 L_p_ok
  s_mov_b64 exec, vcc
  global_load_dwordx4 v[56:59], v110, s[30:31] sc1
  s_mov_b64 exec, -1
  s_waitcnt vmcnt(0)
  s_branch L_p_chk
L_p_ok:
  v_and_b32 v56, s42, v56
  v_and_b32 v57, s42, v57
  v_and_b32 v58, s42, v58
  v_and_b32 v59, s42, v59
  ds_write_b128 v118, v[56:59]
  s_mov_b64 exec, -1
L_pjoin:
  s_waitcnt lgkmcnt(0)
  s_barrier
  s_cmp_lg_u32 s32, 4
  s_cbranch_scc1 L_end
  ds_read_b128 v[80:83], v108 offset:0
  ds_read_b128 v[84:87], v108 offset:1024
  ds_read_b128 v[88:91], v108 offset:2048
  ds_read_b128 v[92:95], v108 offset:3072
  s_waitcnt lgkmcnt(0)
  v_add_f32 v80, v80, v84
  v_add_f32 v81, v81, v85
  v_add_f32 v82, v82, v86
  v_add_f32 v83, v83, v87
  v_add_f32 v88, v88, v92
  v_add_f32 v89, v89, v93
  v_add_f32 v90, v90, v94
  v_add_f32 v91, v91, v95
  v_add_f32 v80, v80, v88
  v_add_f32 v81, v81, v89
  v_add_f32 v82, v82, v90
  v_add_f32 v83, v83, v91
  v_permlane32_swap_b32 v80, v81
  s_nop 0
  v_permlane32_swap_b32 v82, v83
  v_add_f32 v80, v80, v81
  v_add_f32 v82, v82, v83
  s_nop 1
  v_permlane16_swap_b32 v80, v82
  v_add_f32 v80, v80, v82
  s_nop 1
  v_add_f32_dpp v80, v80, v80 row_ror:8 row_mask:0xf bank_mask:0xf
  s_nop 1
  v_add_f32_dpp v80, v80, v80 row_ror:4 row_mask:0xf bank_mask:0xf
  v_add_f32 v80, v80, v116
  v_cvt_pk_bf16_f32 v80, v80, v80
  s_mov_b32 exec_lo, 0x000f000f
  s_mov_b32 exec_hi, 0x000f000f
  global_store_short v117, v80, s[26:27]
  s_mov_b64 exec, 1
  s_cmp_lg_u32 s2, 0
  s_cbranch_scc1 L_noep
  v_mov_b32 v72, 0
  v_mov_b32 v73, s37
  global_store_dword v72, v73, s[30:31]
L_noep:
L_end:
  s_endpgm
.section .rodata,"a"
.p2align 6
.amdhsa_kernel gated_mix__gqa_block_cached__dense_activation_gelu__decode_kernel
  .amdhsa_next_free_vgpr 256
  .amdhsa_next_free_sgpr 102
  .amdhsa_accum_offset 256
  .amdhsa_group_segment_fixed_size 0
  .amdhsa_kernarg_size 112
  .amdhsa_user_sgpr_count 2
  .amdhsa_user_sgpr_kernarg_segment_ptr 1
  .amdhsa_system_sgpr_workgroup_id_x 1
.end_amdhsa_kernel
```
